```python
import torch

def _softmax(x, axis=-1):
    return torch.softmax(x, dim=axis)
def _gelu(x):
    return torch.nn.functional.gelu(x, approximate="tanh")
def _silu(x):
    return torch.nn.functional.silu(x)
def _sigmoid(x):
    return torch.sigmoid(x)
def _layernorm(x, axis=-1, eps=1e-5):
    m = x.mean(dim=axis, keepdim=True)
    v = x.var(dim=axis, keepdim=True, unbiased=False)
    return (x - m) / torch.sqrt(v + eps)
def _scatter_add(tgt, idx, src, axis=0):
    return tgt.clone().index_add_(axis, idx, src)
def _segment_sum(src, seg, n):
    out = torch.zeros((n,) + src.shape[1:], dtype=src.dtype)
    return out.index_add_(0, seg, src)
def _pad(x, pw):
    flat = tuple(v for pair in reversed(pw) for v in pair)
    return torch.nn.functional.pad(x, flat)

kernel_name = 'interleave_layers__sliding_block_cached__moe_arch_mod__decode'

def setup_inputs():

    _w = (lambda a: (lambda t: t.to(torch.bfloat16) if t.is_floating_point() else t)(torch.as_tensor(a)))
    def _A_setup():
        B, Sq, D = 4, 1, 640
        Hq, Hkv, Sk, Dh = 32, 32, 4096, 192
        assert Hq % Hkv == 0, (Hq, Hkv)
        return {
            "x": _w((lambda *s: torch.randn(*s, dtype=torch.bfloat16) * 0.05)(B, Sq, D)),
            "k_cache": _w((lambda *s: torch.randn(*s, dtype=torch.bfloat16) * 1.6)(B, Hkv, Sk, Dh)),
            "v_cache": _w((lambda *s: torch.randn(*s, dtype=torch.bfloat16) * 1.6)(B, Hkv, Sk, Dh)),
            "wq": _w((lambda *s: torch.randn(*s, dtype=torch.bfloat16) * 1.6)(D, Hq * Dh) * (D ** -0.5)),
            "wo": _w((lambda *s: torch.randn(*s, dtype=torch.bfloat16) * 1.6)(Hq * Dh, D) * ((Hq * Dh) ** -0.5)),
        }
    _A_in = _A_setup()

    def _B_setup():
        B, S, D, F, C = 4, 1, 640, 1536, 1
        return {
            "x": _w((lambda *s: torch.randn(*s, dtype=torch.bfloat16) * 0.05)(B, S, D)),
            "w_r": _w((lambda *s: torch.randn(*s, dtype=torch.bfloat16) * 0.05)(D)),
            "w_gate": _w((lambda *s: torch.randn(*s, dtype=torch.bfloat16) * 0.05)(D, F)),
            "w_up": _w((lambda *s: torch.randn(*s, dtype=torch.bfloat16) * 0.05)(D, F)),
            "w_down": _w((lambda *s: torch.randn(*s, dtype=torch.bfloat16) * 0.05)(F, D)),
        }
    _B_in = _B_setup()

    return {
        "A_x": _A_in["x"],
        "A_k_cache": _A_in["k_cache"],
        "A_v_cache": _A_in["v_cache"],
        "A_wq": _A_in["wq"],
        "A_wo": _A_in["wo"],
        "B_x": _B_in["x"],
        "B_w_r": _B_in["w_r"],
        "B_w_gate": _B_in["w_gate"],
        "B_w_up": _B_in["w_up"],
        "B_w_down": _B_in["w_down"],
    }

def reference(A_x, A_k_cache, A_v_cache, A_wq, A_wo, B_x, B_w_r, B_w_gate, B_w_up, B_w_down):
    def _A_ref(x, k_cache, v_cache, wq, wo):
        B, Sq, D = x.shape
        Hq, Dh = 32, 192
        Hkv, Sk = k_cache.shape[1], k_cache.shape[2]
        W = min(4096, max(256, Sk // 4))
        rep = Hq // Hkv
        q = (lambda x, *d: x.permute(*d))((x @ wq).reshape(B, Sq, Hq, Dh), 0, 2, 1, 3)
        k = (lambda x, n, axis: torch.repeat_interleave(x, n, dim=axis))(k_cache[:, :, Sk - W:, :], rep, axis=1)
        v = (lambda x, n, axis: torch.repeat_interleave(x, n, dim=axis))(v_cache[:, :, Sk - W:, :], rep, axis=1)
        scores = torch.einsum("bhqd,bhkd->bhqk", q, k) * (Dh ** -0.5)
        p = _softmax(scores, axis=-1)
        o = torch.einsum("bhqk,bhkd->bhqd", p, v)
        return (lambda x, *d: x.permute(*d))(o, 0, 2, 1, 3).reshape(B, Sq, Hq * Dh) @ wo

    def _B_ref(x, w_r, w_gate, w_up, w_down):
        B, S, D = x.shape
        C = 1
        r = x @ w_r
        idx = torch.argsort(-r, axis=-1)[:, :C]
        idx_e = (lambda x, n, axis: torch.repeat_interleave(x, n, dim=axis))(idx.reshape(B, C, 1), D, axis=2)
        x_sel = (lambda x, i, axis: torch.take_along_dim(x, i, dim=axis))(x, idx_e, axis=1)
        g = _silu(x_sel @ w_gate)
        u = x_sel @ w_up
        y = (g * u) @ w_down
        r_sel = _sigmoid((lambda x, i, axis: torch.take_along_dim(x, i, dim=axis))(r, idx, axis=1))
        y = y * r_sel.reshape(B, C, 1)
        b_off = (torch.arange(B) * S).reshape(B, 1)
        flat_idx = (idx + b_off).reshape(B * C)
        zero = (x * 0.0).reshape(B * S, D)
        upd = _scatter_add(zero, flat_idx, y.reshape(B * C, D), axis=0)
        return x + upd.reshape(B, S, D)

    x = A_x
    x = x + _A_ref(_layernorm(x, axis=-1), A_k_cache, A_v_cache, A_wq, A_wo)
    x = x + _B_ref(_layernorm(x, axis=-1), B_w_r, B_w_gate, B_w_up, B_w_down)
    x = x + _A_ref(_layernorm(x, axis=-1), A_k_cache, A_v_cache, A_wq, A_wo)
    x = x + _B_ref(_layernorm(x, axis=-1), B_w_r, B_w_gate, B_w_up, B_w_down)
    return x
```

```asm
; @launch grid=(256,1,1) block=(512,1,1) lds=137984
.amdgcn_target "amdgcn-amd-amdhsa--gfx950"
.text
.globl interleave_layers__sliding_block_cached__moe_arch_mod__decode_kernel
.p2align 8
.type interleave_layers__sliding_block_cached__moe_arch_mod__decode_kernel,@function
interleave_layers__sliding_block_cached__moe_arch_mod__decode_kernel:
    s_cmpk_ge_u32 s2, 0x100
    s_cbranch_scc1 L_end
    s_load_dwordx16 s[32:47], s[0:1], 0
    s_getpc_b64 s[70:71]
L_pc0:
    s_and_b32 s69, s2, 0xf8
    v_lshlrev_b32 v7, 1, v0
    v_lshl_add_u32 v7, s69, 7, v7
    v_min_u32 v7, L_codeend-L_pc0-4, v7
    s_mov_b64 exec, 1
    global_load_dword v7, v7, s[70:71]
    s_mov_b64 exec, -1
    v_lshrrev_b32 v1, 6, v0
    v_and_b32 v0, 63, v0
    s_lshl_b32 s63, s2, 7
    v_readfirstlane_b32 s3, v1
    s_and_b32 s63, s63, 0x1800
    s_lshl_b32 s64, s2, 8
    s_and_b32 s64, s64, 0x700
    s_and_b32 s66, s2, 0xc8
    s_or_b32 s63, s63, s64
    s_or_b32 s66, s66, s63
    s_add_u32 s66, s66, s3
    s_addk_i32 s66, 48
    s_mulk_i32 s66, 24576
    v_bfe_u32 v11, v0, 2, 2
    v_mul_u32_u24 v60, 768, v11
    v_and_b32 v12, 48, v0
    v_lshl_add_u32 v60, v12, 2, v60
    v_and_b32 v10, 3, v0
    v_lshl_add_u32 v60, v10, 4, v60
    s_movk_i32 s22, 24576
    s_mov_b32 s23, 0x20000
    s_waitcnt lgkmcnt(0)
    s_add_u32 s20, s34, s66
    s_addc_u32 s21, s35, 0
    buffer_load_dwordx4 a[0:3], v60, s[20:23], 0 offen offset:0 nt
    buffer_load_dwordx4 a[4:7], v60, s[20:23], 0 offen offset:256 nt
    buffer_load_dwordx4 a[8:11], v60, s[20:23], 0 offen offset:512 nt
    buffer_load_dwordx4 a[12:15], v60, s[20:23], 0 offen offset:3072 nt
    buffer_load_dwordx4 a[16:19], v60, s[20:23], 0 offen offset:3328 nt
    buffer_load_dwordx4 a[20:23], v60, s[20:23], 0 offen offset:3584 nt
    s_load_dwordx8 s[48:55], s[0:1], 64
    s_load_dwordx2 s[56:57], s[0:1], 96
    s_mov_b64 exec, 1
    v_mov_b32 v14, 576
    v_mov_b64 v[16:17], 0
    v_mov_b64 v[18:19], 0
    ds_write_b128 v14, v[16:19]
    s_mov_b64 exec, -1
    s_and_b32 s4, s2, 7
    s_lshr_b32 s5, s2, 3
    s_lshr_b32 s6, s5, 3
    s_bfe_u32 s72, s5, 0x20001
    s_and_b32 s62, s5, 1
    s_movk_i32 s63, 6144
    s_movk_i32 s64, 12288
    s_movk_i32 s65, 18432
    v_lshrrev_b32 v8, 4, v0
    v_and_b32 v9, 15, v0
    v_bfe_u32 v12, v0, 4, 1
    v_mul_u32_u24 v61, 3072, v12
    v_lshrrev_b32 v12, 5, v0
    v_mul_u32_u24 v12, 768, v12
    v_lshl_add_u32 v61, v9, 4, v61
    v_add_u32 v61, v61, v12
    s_add_u32 s24, s36, s66
    s_addc_u32 s25, s37, 0
    s_movk_i32 s26, 24576
    s_mov_b32 s27, 0x20000
    s_waitcnt lgkmcnt(0)
    s_barrier
    s_cmp_ge_u32 s3, 5
    s_cbranch_scc0 L_early
    s_cmp_eq_u32 s3, 7
    s_cbranch_scc1 L_aside1
L_ret2:
    s_setprio 1
    buffer_load_dwordx4 a[24:27], v60, s[20:23], s63 offen offset:0 nt
    s_nop 0
    buffer_load_dwordx4 a[28:31], v60, s[20:23], s63 offen offset:256 nt
    s_nop 0
    buffer_load_dwordx4 a[32:35], v60, s[20:23], s63 offen offset:512 nt
    s_nop 0
    buffer_load_dwordx4 a[36:39], v60, s[20:23], s63 offen offset:3072 nt
    s_nop 0
    buffer_load_dwordx4 a[40:43], v60, s[20:23], s63 offen offset:3328 nt
    s_nop 0
    buffer_load_dwordx4 a[44:47], v60, s[20:23], s63 offen offset:3584 nt
    s_nop 0
    buffer_load_dwordx4 a[48:51], v60, s[20:23], s64 offen offset:0 nt
    s_nop 0
    buffer_load_dwordx4 a[52:55], v60, s[20:23], s64 offen offset:256 nt
    s_nop 0
    buffer_load_dwordx4 a[56:59], v60, s[20:23], s64 offen offset:512 nt
    s_nop 0
    buffer_load_dwordx4 a[60:63], v60, s[20:23], s64 offen offset:3072 nt
    s_nop 0
    buffer_load_dwordx4 a[64:67], v60, s[20:23], s64 offen offset:3328 nt
    s_nop 0
    buffer_load_dwordx4 a[68:71], v60, s[20:23], s64 offen offset:3584 nt
    s_nop 0
    buffer_load_dwordx4 a[72:75], v60, s[20:23], s65 offen offset:0 nt
    s_nop 0
    buffer_load_dwordx4 a[76:79], v60, s[20:23], s65 offen offset:256 nt
    s_nop 0
    buffer_load_dwordx4 a[80:83], v60, s[20:23], s65 offen offset:512 nt
    s_nop 0
    buffer_load_dwordx4 a[84:87], v60, s[20:23], s65 offen offset:3072 nt
    s_nop 0
    buffer_load_dwordx4 a[88:91], v60, s[20:23], s65 offen offset:3328 nt
    s_nop 0
    buffer_load_dwordx4 a[92:95], v60, s[20:23], s65 offen offset:3584 nt
    s_nop 0
    buffer_load_dwordx4 a[96:99], v61, s[24:27], 0 offen offset:0 nt
    s_nop 0
    buffer_load_dwordx4 a[100:103], v61, s[24:27], 0 offen offset:1536 nt
    s_nop 0
    buffer_load_dwordx4 a[104:107], v61, s[24:27], 0 offen offset:256 nt
    s_nop 0
    buffer_load_dwordx4 a[108:111], v61, s[24:27], 0 offen offset:1792 nt
    s_nop 0
    buffer_load_dwordx4 a[112:115], v61, s[24:27], 0 offen offset:512 nt
    s_nop 0
    buffer_load_dwordx4 a[116:119], v61, s[24:27], 0 offen offset:2048 nt
    s_nop 0
    buffer_load_dwordx4 a[120:123], v61, s[24:27], s63 offen offset:0 nt
    s_nop 0
    buffer_load_dwordx4 a[124:127], v61, s[24:27], s63 offen offset:1536 nt
    s_nop 0
    buffer_load_dwordx4 a[128:131], v61, s[24:27], s63 offen offset:256 nt
    s_nop 0
    buffer_load_dwordx4 a[132:135], v61, s[24:27], s63 offen offset:1792 nt
    s_nop 0
    buffer_load_dwordx4 a[136:139], v61, s[24:27], s63 offen offset:512 nt
    s_nop 0
    buffer_load_dwordx4 a[140:143], v61, s[24:27], s63 offen offset:2048 nt
    s_nop 0
    buffer_load_dwordx4 a[144:147], v61, s[24:27], s64 offen offset:0 nt
    s_nop 0
    buffer_load_dwordx4 a[148:151], v61, s[24:27], s64 offen offset:1536 nt
    s_nop 0
    buffer_load_dwordx4 a[152:155], v61, s[24:27], s64 offen offset:256 nt
    s_nop 0
    buffer_load_dwordx4 a[156:159], v61, s[24:27], s64 offen offset:1792 nt
    s_nop 0
    buffer_load_dwordx4 a[160:163], v61, s[24:27], s64 offen offset:512 nt
    s_nop 0
    buffer_load_dwordx4 a[164:167], v61, s[24:27], s64 offen offset:2048 nt
    s_nop 0
    buffer_load_dwordx4 a[168:171], v61, s[24:27], s65 offen offset:0 nt
    s_nop 0
    buffer_load_dwordx4 a[172:175], v61, s[24:27], s65 offen offset:1536 nt
    s_nop 0
    buffer_load_dwordx4 a[176:179], v61, s[24:27], s65 offen offset:256 nt
    s_nop 0
    buffer_load_dwordx4 a[180:183], v61, s[24:27], s65 offen offset:1792 nt
    s_nop 0
    buffer_load_dwordx4 a[184:187], v61, s[24:27], s65 offen offset:512 nt
    s_nop 0
    buffer_load_dwordx4 a[188:191], v61, s[24:27], s65 offen offset:2048 nt
    s_nop 0
    s_and_b32 s7, s5, 7
    s_lshl_b32 s11, s62, 2
    s_add_u32 s11, s11, s72
    s_and_b32 s60, s3, 1
    s_lshr_b32 s61, s3, 1
    s_mov_b32 s74, 0x80000000
    s_mov_b32 s10, 0x100000
    s_mov_b32 s8, 0
    s_mov_b32 s9, 0
    s_mov_b32 s73, 0x3dd53b95
    s_mul_i32 s58, s4, 27136
    s_lshl_b32 s59, s5, 12
    s_add_u32 s59, s59, 217088
    s_mov_b32 s12, s56
    s_mov_b32 s13, s57
    s_mov_b32 s14, 2689152
    s_mov_b32 s15, 0x20000
    v_lshl_add_u32 v2, v8, 3, v11
    v_lshlrev_b32 v2, 5, v2
    v_lshl_add_u32 v2, v10, 3, v2
    v_lshlrev_b32 v3, 4, v0
    v_mov_b32 v13, s74
    v_cmp_gt_u32 vcc, 4, v9
    v_lshlrev_b32 v1, 6, v8
    v_lshl_add_u32 v1, v9, 4, v1
    v_cndmask_b32 v1, v13, v1, vcc
    s_waitcnt vmcnt(42)
    s_branch L_kvcount
L_early:
    s_cmp_eq_u32 s3, 0
    s_cbranch_scc1 L_ctl
    s_setprio 2
    s_mov_b32 s16, s38
    s_mov_b32 s17, s39
    s_mov_b32 s18, 7864320
    s_mov_b32 s19, 0x20000
    v_add_u32 v14, 0, v0
    v_mul_u32_u24 v15, 2731, v14
    v_lshrrev_b32 v15, 16, v15
    v_mul_u32_u24 v16, 24, v15
    v_sub_u32 v14, v14, v16
    v_mul_u32_u24 v15, 12288, v15
    v_lshl_add_u32 v56, v14, 4, v15
    v_add_u32 v14, 64, v0
    v_mul_u32_u24 v15, 2731, v14
    v_lshrrev_b32 v15, 16, v15
    v_mul_u32_u24 v16, 24, v15
    v_sub_u32 v14, v14, v16
    v_mul_u32_u24 v15, 12288, v15
    v_lshl_add_u32 v57, v14, 4, v15
    v_add_u32 v14, 128, v0
    v_mul_u32_u24 v15, 2731, v14
    v_lshrrev_b32 v15, 16, v15
    v_mul_u32_u24 v16, 24, v15
    v_sub_u32 v14, v14, v16
    v_mul_u32_u24 v15, 12288, v15
    v_lshl_add_u32 v58, v14, 4, v15
    s_lshl_b32 s70, s3, 3
    s_sub_u32 s70, s70, 8
    s_lshr_b32 s69, 0x48203800, s70
    s_and_b32 s69, s69, 255
    s_and_b32 s70, s5, 7
    s_mul_i32 s67, s70, 983040
    s_mul_i32 s71, s69, 12288
    s_add_u32 s67, s67, s71
    s_mul_i32 s71, s4, 1536
    s_add_u32 s67, s67, s71
    s_mul_i32 s71, s6, 384
    s_add_u32 s67, s67, s71
    s_mul_i32 s68, s69, 384
    s_add_u32 s68, s68, 33152
    s_mov_b32 m0, s68
    s_add_u32 s68, s68, 1024
    buffer_load_dwordx4 v56, s[16:19], s67 offen nt lds
    s_mov_b32 m0, s68
    s_add_u32 s68, s68, 1024
    buffer_load_dwordx4 v57, s[16:19], s67 offen nt lds
    s_mov_b32 m0, s68
    s_add_u32 s68, s68, 1024
    buffer_load_dwordx4 v58, s[16:19], s67 offen nt lds
    s_add_u32 s67, s67, 98304
    s_cmp_eq_u32 s3, 4
    s_cbranch_scc1 L_wqdone
    s_mov_b32 m0, s68
    s_add_u32 s68, s68, 1024
    buffer_load_dwordx4 v56, s[16:19], s67 offen nt lds
    s_mov_b32 m0, s68
    s_add_u32 s68, s68, 1024
    buffer_load_dwordx4 v57, s[16:19], s67 offen nt lds
    s_mov_b32 m0, s68
    s_add_u32 s68, s68, 1024
    buffer_load_dwordx4 v58, s[16:19], s67 offen nt lds
    s_add_u32 s67, s67, 98304
    s_cmp_eq_u32 s3, 2
    s_cbranch_scc1 L_wqdone
    s_mov_b32 m0, s68
    s_add_u32 s68, s68, 1024
    buffer_load_dwordx4 v56, s[16:19], s67 offen nt lds
    s_mov_b32 m0, s68
    s_add_u32 s68, s68, 1024
    buffer_load_dwordx4 v57, s[16:19], s67 offen nt lds
    s_mov_b32 m0, s68
    s_add_u32 s68, s68, 1024
    buffer_load_dwordx4 v58, s[16:19], s67 offen nt lds
    s_add_u32 s67, s67, 98304
    s_cmp_eq_u32 s3, 3
    s_cbranch_scc1 L_wqdone
    s_mov_b32 m0, s68
    s_add_u32 s68, s68, 1024
    buffer_load_dwordx4 v56, s[16:19], s67 offen nt lds
    s_mov_b32 m0, s68
    s_add_u32 s68, s68, 1024
    buffer_load_dwordx4 v57, s[16:19], s67 offen nt lds
    s_mov_b32 m0, s68
    s_add_u32 s68, s68, 1024
    buffer_load_dwordx4 v58, s[16:19], s67 offen nt lds
    s_add_u32 s67, s67, 98304
L_wqdone:
    buffer_load_dwordx4 a[24:27], v60, s[20:23], s63 offen offset:0 nt
    s_nop 0
    buffer_load_dwordx4 a[28:31], v60, s[20:23], s63 offen offset:256 nt
    s_nop 0
    buffer_load_dwordx4 a[32:35], v60, s[20:23], s63 offen offset:512 nt
    s_nop 0
    buffer_load_dwordx4 a[36:39], v60, s[20:23], s63 offen offset:3072 nt
    s_nop 0
    buffer_load_dwordx4 a[40:43], v60, s[20:23], s63 offen offset:3328 nt
    s_nop 0
    buffer_load_dwordx4 a[44:47], v60, s[20:23], s63 offen offset:3584 nt
    s_nop 0
    buffer_load_dwordx4 a[48:51], v60, s[20:23], s64 offen offset:0 nt
    s_nop 0
    buffer_load_dwordx4 a[52:55], v60, s[20:23], s64 offen offset:256 nt
    s_nop 0
    buffer_load_dwordx4 a[56:59], v60, s[20:23], s64 offen offset:512 nt
    s_nop 0
    buffer_load_dwordx4 a[60:63], v60, s[20:23], s64 offen offset:3072 nt
    s_nop 0
    buffer_load_dwordx4 a[64:67], v60, s[20:23], s64 offen offset:3328 nt
    s_nop 0
    buffer_load_dwordx4 a[68:71], v60, s[20:23], s64 offen offset:3584 nt
    s_nop 0
    buffer_load_dwordx4 a[72:75], v60, s[20:23], s65 offen offset:0 nt
    s_nop 0
    buffer_load_dwordx4 a[76:79], v60, s[20:23], s65 offen offset:256 nt
    s_nop 0
    s_waitcnt vmcnt(14)
    s_mov_b64 exec, 1
    v_mov_b32 v14, 576
    v_mov_b32 v15, 1
    ds_add_u32 v14, v15 offset:0
    s_mov_b64 exec, -1
    buffer_load_dwordx4 a[80:83], v60, s[20:23], s65 offen offset:512 nt
    s_nop 0
    buffer_load_dwordx4 a[84:87], v60, s[20:23], s65 offen offset:3072 nt
    s_nop 0
    buffer_load_dwordx4 a[88:91], v60, s[20:23], s65 offen offset:3328 nt
    s_nop 0
    buffer_load_dwordx4 a[92:95], v60, s[20:23], s65 offen offset:3584 nt
    s_nop 0
    buffer_load_dwordx4 a[96:99], v61, s[24:27], 0 offen offset:0 nt
    s_nop 0
    buffer_load_dwordx4 a[100:103], v61, s[24:27], 0 offen offset:1536 nt
    s_nop 0
    buffer_load_dwordx4 a[104:107], v61, s[24:27], 0 offen offset:256 nt
    s_nop 0
    buffer_load_dwordx4 a[108:111], v61, s[24:27], 0 offen offset:1792 nt
    s_nop 0
    buffer_load_dwordx4 a[112:115], v61, s[24:27], 0 offen offset:512 nt
    s_nop 0
    buffer_load_dwordx4 a[116:119], v61, s[24:27], 0 offen offset:2048 nt
    s_nop 0
    buffer_load_dwordx4 a[120:123], v61, s[24:27], s63 offen offset:0 nt
    s_nop 0
    buffer_load_dwordx4 a[124:127], v61, s[24:27], s63 offen offset:1536 nt
    s_nop 0
    buffer_load_dwordx4 a[128:131], v61, s[24:27], s63 offen offset:256 nt
    s_nop 0
    buffer_load_dwordx4 a[132:135], v61, s[24:27], s63 offen offset:1792 nt
    s_nop 0
    buffer_load_dwordx4 a[136:139], v61, s[24:27], s63 offen offset:512 nt
    s_nop 0
    buffer_load_dwordx4 a[140:143], v61, s[24:27], s63 offen offset:2048 nt
    s_nop 0
    s_and_b32 s7, s5, 7
    s_lshl_b32 s11, s62, 2
    s_add_u32 s11, s11, s72
    s_and_b32 s60, s3, 1
    s_lshr_b32 s61, s3, 1
    s_mov_b32 s74, 0x80000000
    s_mov_b32 s10, 0x100000
    s_mov_b32 s8, 0
    s_mov_b32 s9, 0
    s_mov_b32 s73, 0x3dd53b95
    s_mul_i32 s58, s4, 27136
    s_lshl_b32 s59, s5, 12
    s_add_u32 s59, s59, 217088
    s_mov_b32 s12, s56
    s_mov_b32 s13, s57
    s_mov_b32 s14, 2689152
    s_mov_b32 s15, 0x20000
    v_lshl_add_u32 v2, v8, 3, v11
    v_lshlrev_b32 v2, 5, v2
    v_lshl_add_u32 v2, v10, 3, v2
    v_lshlrev_b32 v3, 4, v0
    v_mov_b32 v13, s74
    v_cmp_gt_u32 vcc, 4, v9
    v_lshlrev_b32 v1, 6, v8
    v_lshl_add_u32 v1, v9, 4, v1
    v_cndmask_b32 v1, v13, v1, vcc
    s_cmp_eq_u32 s3, 2
    s_cbranch_scc1 L_gat
    buffer_load_dwordx4 a[144:147], v61, s[24:27], s64 offen offset:0 nt
    s_nop 0
    buffer_load_dwordx4 a[148:151], v61, s[24:27], s64 offen offset:1536 nt
    s_nop 0
    buffer_load_dwordx4 a[152:155], v61, s[24:27], s64 offen offset:256 nt
    s_nop 0
    buffer_load_dwordx4 a[156:159], v61, s[24:27], s64 offen offset:1792 nt
    s_nop 0
    buffer_load_dwordx4 a[160:163], v61, s[24:27], s64 offen offset:512 nt
    s_nop 0
    buffer_load_dwordx4 a[164:167], v61, s[24:27], s64 offen offset:2048 nt
    s_nop 0
    buffer_load_dwordx4 a[168:171], v61, s[24:27], s65 offen offset:0 nt
    s_nop 0
    buffer_load_dwordx4 a[172:175], v61, s[24:27], s65 offen offset:1536 nt
    s_nop 0
    buffer_load_dwordx4 a[176:179], v61, s[24:27], s65 offen offset:256 nt
    s_nop 0
    buffer_load_dwordx4 a[180:183], v61, s[24:27], s65 offen offset:1792 nt
    s_nop 0
    buffer_load_dwordx4 a[184:187], v61, s[24:27], s65 offen offset:512 nt
    s_nop 0
    buffer_load_dwordx4 a[188:191], v61, s[24:27], s65 offen offset:2048 nt
    s_nop 0
    s_setprio 0
    s_cmp_eq_u32 s3, 1
    s_cbranch_scc0 L_kvdone
    v_bfe_u32 v12, v0, 3, 1
    v_bfe_u32 v14, v0, 2, 1
    v_and_b32 v15, 7, v0
    v_lshrrev_b32 v20, 5, v0
    v_bfe_u32 v21, v0, 4, 1
    v_lshl_add_u32 v22, v8, 2, v10
    v_lshlrev_b32 v22, 4, v22
    v_add_u32 v22, 128, v22
    v_mov_b32 v23, 512
    v_mov_b32 v24, v22
    v_mul_u32_u24 v25, 384, v12
    v_sub_u32 v25, v22, v25
    v_add_u32 v25, 256, v25
    v_add_u32 v26, 128, v22
    v_cmp_eq_u32 vcc, 0, v12
    s_nop 1
    v_cndmask_b32 v24, v23, v24, vcc
    v_cmp_eq_u32 vcc, v20, v12
    s_nop 1
    v_cndmask_b32 v25, v23, v25, vcc
    v_cmp_eq_u32 vcc, 1, v12
    s_nop 1
    v_cndmask_b32 v26, v23, v26, vcc
    v_cmp_eq_u32 vcc, 0, v14
    s_nop 1
    v_cndmask_b32 v16, v23, v24, vcc
    v_cndmask_b32 v17, v23, v25, vcc
    v_cndmask_b32 v18, v23, v26, vcc
    v_cndmask_b32 v19, v24, v23, vcc
    ds_write_b128 v3, v[16:19] offset:9600
    v_cndmask_b32 v16, v25, v23, vcc
    v_cndmask_b32 v17, v26, v23, vcc
    ds_write_b128 v3, v[16:19] offset:10624
    v_lshlrev_b32 v24, 5, v9
    v_lshl_add_u32 v24, v21, 4, v24
    v_add_u32 v24, 19840, v24
    v_add_u32 v23, 125312, v3
    v_mov_b32 v16, v24
    v_add_u32 v17, 512, v24
    v_add_u32 v18, 1024, v24
    v_mov_b32 v19, 0
    v_cmp_eq_u32 vcc, 0, v20
    s_nop 1
    v_cndmask_b32 v16, v23, v16, vcc
    v_cmp_eq_u32 vcc, v12, v20
    s_nop 1
    v_cndmask_b32 v17, v23, v17, vcc
    v_cmp_eq_u32 vcc, 1, v20
    s_nop 1
    v_cndmask_b32 v18, v23, v18, vcc
    v_cmp_eq_u32 vcc, 63, v0
    s_nop 1
    v_cndmask_b32 v19, v23, v19, vcc
    ds_write_b128 v3, v[16:19] offset:18816
    v_mul_u32_u24 v16, 0x5555, v10
    v_lshl_add_u32 v19, v8, 3, v11
    v_lshlrev_b32 v19, 6, v19
    v_lshl_add_u32 v19, v10, 3, v19
    v_add_u32 v19, 63872, v19
    ds_write_b128 v3, v[16:19] offset:11648
    v_lshrrev_b32 v22, 3, v0
    v_mul_u32_u24 v16, 1664, v22
    v_lshl_add_u32 v16, v15, 4, v16
    v_add_u32 v16, 19840, v16
    v_lshlrev_b32 v17, 4, v22
    v_lshrrev_b32 v18, 1, v15
    v_lshlrev_b32 v18, 7, v18
    v_and_b32 v22, 1, v0
    v_lshl_add_u32 v18, v22, 3, v18
    v_lshl_add_u32 v18, v20, 2, v18
    v_and_b32 v23, 31, v0
    v_cmp_gt_u32 vcc, 6, v23
    s_nop 1
    v_cndmask_b32 v18, v13, v18, vcc
    v_mov_b32 v19, 0
    v_cmp_eq_u32 vcc, 63, v0
    s_nop 1
    v_cndmask_b32 v19, v13, v19, vcc
    ds_write_b128 v3, v[16:19] offset:12672
    v_lshlrev_b32 v16, 7, v8
    v_lshl_add_u32 v16, v9, 4, v16
    v_lshlrev_b32 v17, 3, v9
    v_lshlrev_b32 v18, 6, v9
    v_lshl_add_u32 v18, v8, 4, v18
    v_add_u32 v19, 1408, v18
    v_add_u32 v18, 5504, v18
    v_cmp_gt_u32 vcc, 8, v9
    s_nop 1
    v_cndmask_b32 v16, v13, v16, vcc
    v_cndmask_b32 v17, v13, v17, vcc
    v_add_u32 v23, 125312, v3
    v_cmp_gt_u32 vcc, 4, v9
    s_nop 1
    v_cndmask_b32 v18, v23, v18, vcc
    v_cndmask_b32 v27, v23, v19, vcc
    v_lshrrev_b32 v19, 2, v0
    v_mul_u32_u24 v19, 1280, v19
    v_lshl_add_u32 v19, v10, 4, v19
    ds_write_b128 v3, v[16:19] offset:13696
    v_lshlrev_b32 v16, 6, v8
    v_lshl_add_u32 v16, v12, 11, v16
    v_lshl_add_u32 v16, v14, 8, v16
    v_lshl_add_u32 v16, v10, 4, v16
    v_add_u32 v16, 5504, v16
    v_lshlrev_b32 v17, 6, v8
    v_lshl_add_u32 v17, v14, 8, v17
    v_lshl_add_u32 v17, v10, 4, v17
    s_lshr_b32 s69, s4, 2
    v_xor_b32 v18, s69, v12
    v_lshl_add_u32 v18, v18, 11, v17
    v_cmp_eq_u32 vcc, 0, v12
    s_nop 1
    v_cndmask_b32 v17, v13, v17, vcc
    v_lshrrev_b32 v19, 1, v15
    v_lshlrev_b32 v19, 6, v19
    v_lshl_add_u32 v19, v8, 4, v19
    v_lshl_add_u32 v19, v22, 3, v19
    v_lshl_add_u32 v19, v12, 2, v19
    ds_write_b128 v3, v[16:19] offset:14720
    v_lshlrev_b32 v16, 2, v11
    v_lshl_add_u32 v16, v8, 4, v16
    v_cmp_eq_u32 vcc, 0, v10
    s_nop 1
    v_cndmask_b32 v16, v13, v16, vcc
    v_mul_u32_u24 v17, 1280, v8
    v_lshl_add_u32 v17, v15, 3, v17
    v_lshl_add_u32 v17, v12, 2, v17
    v_lshlrev_b32 v18, 6, v9
    v_lshl_add_u32 v18, v8, 4, v18
    v_add_u32 v19, 1024, v18
    v_cmp_gt_u32 vcc, 4, v9
    s_nop 1
    v_cndmask_b32 v19, v13, v19, vcc
    ds_write_b128 v3, v[16:19] offset:15744
    v_mov_b32 v28, s5
    v_mov_b32 v16, v27
    v_lshlrev_b32 v17, 9, v11
    v_lshl_add_u32 v17, v8, 6, v17
    v_lshl_add_u32 v17, v10, 4, v17
    v_add_u32 v17, 1408, v17
    v_lshrrev_b32 v18, 1, v10
    v_lshlrev_b32 v18, 6, v18
    v_lshl_add_u32 v18, v8, 4, v18
    v_lshl_add_u32 v18, v22, 3, v18
    v_lshl_add_u32 v18, v11, 1, v18
    v_cmp_eq_u32 vcc, 0, v14
    s_nop 1
    v_cndmask_b32 v18, v13, v18, vcc
    v_lshlrev_b32 v19, 6, v9
    v_lshl_add_u32 v19, v8, 4, v19
    v_cmp_gt_u32 vcc, 4, v9
    s_nop 1
    v_cndmask_b32 v19, v13, v19, vcc
    v_lshrrev_b32 v23, 1, v0
    v_mul_u32_u24 v23, 3072, v23
    v_lshl_add_u32 v23, v22, 4, v23
    v_cmp_gt_u32 vcc, 20, v28
    s_nop 1
    v_cndmask_b32 v19, v23, v19, vcc
    ds_write_b128 v3, v[16:19] offset:16768
    v_mov_b32 v16, v1
    v_cmp_gt_u32 vcc, 32, v0
    s_nop 1
    v_cndmask_b32 v16, v13, v16, vcc
    v_mul_u32_u24 v17, 6144, v9
    v_lshl_add_u32 v17, v8, 4, v17
    v_cmp_gt_u32 vcc, 4, v9
    s_nop 1
    v_cndmask_b32 v17, v13, v17, vcc
    v_lshrrev_b32 v18, 4, v0
    v_lshlrev_b32 v18, 3, v18
    v_bfe_u32 v19, v0, 2, 2
    v_add_u32 v18, v18, v19
    v_mul_u32_u24 v18, 384, v18
    v_and_b32 v19, 3, v0
    v_lshl_add_u32 v18, v19, 3, v18
    v_add_u32 v18, 33152, v18
    v_lshrrev_b32 v19, 5, v0
    v_mul_u32_u24 v19, 6144, v19
    v_sub_u32 v19, v18, v19
    ds_write_b128 v3, v[16:19] offset:17792
    s_mov_b64 exec, 1
    v_mov_b32 v14, 576
    v_mov_b32 v15, 1
    s_waitcnt lgkmcnt(0)
    ds_add_u32 v14, v15 offset:4
    s_mov_b64 exec, -1
    s_setprio 3
    v_mov_b32 v14, 576
L_retry3:
    s_sub_u32 s10, s10, 1
    s_cbranch_scc1 L_give5
    s_sleep 4
    ds_read_b32 v15, v14 offset:8
    s_waitcnt lgkmcnt(0)
    v_cmp_ne_u32 vcc, 2, v15
    s_cbranch_vccnz L_retry3
L_ok4:
    v_mov_b32 v28, 592
    ds_read_b64 v[28:29], v28
    s_mov_b32 s68, 2686976
    s_waitcnt lgkmcnt(0)
    v_readfirstlane_b32 s42, v28
    v_readfirstlane_b32 s43, v29
L_retry6:
    s_sub_u32 s10, s10, 1
    s_cbranch_scc1 L_give8
    buffer_load_dwordx4 v[40:43], v3, s[12:15], s68 offen sc1
    buffer_load_dwordx4 v[44:47], v3, s[12:15], s68 offen offset:1024 sc1
    v_mov_b32 v30, 0
    s_waitcnt vmcnt(0)
    v_xor_b32 v28, s42, v40
    v_subrev_u32 v29, s43, v41
    v_lshrrev_b32 v29, 4, v29
    v_or3_b32 v30, v30, v28, v29
    v_xor_b32 v28, s42, v42
    v_subrev_u32 v29, s43, v43
    v_lshrrev_b32 v29, 4, v29
    v_or3_b32 v30, v30, v28, v29
    v_xor_b32 v28, s42, v44
    v_subrev_u32 v29, s43, v45
    v_lshrrev_b32 v29, 4, v29
    v_or3_b32 v30, v30, v28, v29
    v_xor_b32 v28, s42, v46
    v_subrev_u32 v29, s43, v47
    v_lshrrev_b32 v29, 4, v29
    v_or3_b32 v30, v30, v28, v29
    v_cmp_ne_u32 vcc, 0, v30
    s_cbranch_vccz L_arrived
    s_sleep 16
    s_branch L_retry6
L_ok7:
L_arrived:
    s_getreg_b32 s67, hwreg(HW_REG_XCC_ID, 0, 4)
    s_add_u32 s67, s67, s43
    s_cmp_ge_u32 s4, 4
    s_cselect_b64 vcc, -1, 0
    v_cndmask_b32 v41, v41, v45, vcc
    v_cndmask_b32 v43, v43, v47, vcc
    v_xor_b32 v41, s67, v41
    v_xor_b32 v43, s67, v43
    v_or_b32 v41, v41, v43
    v_cmp_ne_u32 vcc, 0, v41
    s_and_b32 s68, s4, 3
    s_lshl_b32 s68, s68, 4
    s_lshr_b64 s[68:69], vcc, s68
    s_and_b32 s68, s68, 0xffff
    s_cselect_b32 s68, 0, 1
    v_mov_b32 v29, s68
    s_mov_b32 exec_lo, 0xff
    s_mov_b32 exec_hi, 0x0
    ds_write_b32 v3, v29 offset:8
    s_mov_b64 exec, -1
    s_mov_b32 s9, s68
    s_cmp_lt_u32 s5, 20
    s_cbranch_scc0 L_nolc
    s_mul_i32 s67, s4, 20480
    s_lshl_b32 s71, s5, 10
    s_add_u32 s67, s67, s71
    s_add_u32 s67, s67, 393216
    v_mov_b32 v24, -1
    v_mov_b32 v25, -1
    v_mov_b32 v26, -1
    v_mov_b32 v27, -1
    s_cmp_eq_u32 s9, 0
    s_cbranch_scc1 L_slow9
    buffer_store_dwordx4 v[24:27], v3, s[12:15], s67 offen
L_back10:
    buffer_load_dwordx4 v[44:47], v3, s[12:15], s67 offen sc1
    s_waitcnt vmcnt(0)
L_nolc:
    s_setprio 0
    s_branch L_kvdone
L_gat:
    s_setprio 3
    v_mov_b32 v14, 576
L_retry11:
    s_sub_u32 s10, s10, 1
    s_cbranch_scc1 L_give13
    s_sleep 4
    ds_read_b32 v15, v14 offset:8
    s_waitcnt lgkmcnt(0)
    v_cmp_ne_u32 vcc, 2, v15
    s_cbranch_vccnz L_retry11
L_ok12:
    ds_read_b64 v[14:15], v14 offset:16
    s_mul_i32 s70, s4, 98304
    s_mul_i32 s71, s6, 24576
    s_add_u32 s70, s70, s71
    s_mul_i32 s71, s72, 6144
    s_add_u32 s70, s70, s71
    s_add_u32 s70, s70, 1507328
    s_add_u32 s69, s70, 3072
    v_lshlrev_b32 v53, 3, v0
    v_mov_b32 v54, 0x3f80
    v_mov_b32 v55, 0x3f800000
    s_mov_b32 exec_lo, 0xffffffff
    s_mov_b32 exec_hi, 0xffff
L_retry14:
    s_sub_u32 s10, s10, 1
    s_cbranch_scc1 L_give16
    buffer_load_dwordx4 v[16:19], v3, s[12:15], s70 offen offset:0 sc1
    buffer_load_dwordx4 v[20:23], v3, s[12:15], s70 offen offset:768 sc1
    buffer_load_dwordx4 v[24:27], v3, s[12:15], s70 offen offset:1536 sc1
    buffer_load_dwordx4 v[28:31], v3, s[12:15], s70 offen offset:2304 sc1
    buffer_load_dwordx4 v[32:35], v3, s[12:15], s69 offen offset:0 sc1
    buffer_load_dwordx4 v[36:39], v3, s[12:15], s69 offen offset:768 sc1
    buffer_load_dwordx4 v[40:43], v3, s[12:15], s69 offen offset:1536 sc1
    buffer_load_dwordx4 v[44:47], v3, s[12:15], s69 offen offset:2304 sc1
    v_mov_b32 v56, 0
    s_waitcnt vmcnt(0) lgkmcnt(0)
    v_xor_b32 v18, v14, v18
    v_xor_b32 v19, v15, v19
    v_or3_b32 v56, v56, v18, v19
    v_xor_b32 v22, v14, v22
    v_xor_b32 v23, v15, v23
    v_or3_b32 v56, v56, v22, v23
    v_xor_b32 v26, v14, v26
    v_xor_b32 v27, v15, v27
    v_or3_b32 v56, v56, v26, v27
    v_xor_b32 v30, v14, v30
    v_xor_b32 v31, v15, v31
    v_or3_b32 v56, v56, v30, v31
    v_xor_b32 v34, v14, v34
    v_xor_b32 v35, v15, v35
    v_or3_b32 v56, v56, v34, v35
    v_xor_b32 v38, v14, v38
    v_xor_b32 v39, v15, v39
    v_or3_b32 v56, v56, v38, v39
    v_xor_b32 v42, v14, v42
    v_xor_b32 v43, v15, v43
    v_or3_b32 v56, v56, v42, v43
    v_xor_b32 v46, v14, v46
    v_xor_b32 v47, v15, v47
    v_or3_b32 v56, v56, v46, v47
    v_cmp_ne_u32 vcc, 0, v56
    s_cbranch_vccnz L_retry14
L_ok15:
    v_dot2_f32_bf16 v48, v16, v54, 0
    v_dot2_f32_bf16 v49, v16, v55, 0
    v_dot2_f32_bf16 v50, v17, v54, 0
    v_dot2_f32_bf16 v51, v17, v55, 0
    v_dot2_f32_bf16 v48, v20, v54, v48
    v_dot2_f32_bf16 v49, v20, v55, v49
    v_dot2_f32_bf16 v50, v21, v54, v50
    v_dot2_f32_bf16 v51, v21, v55, v51
    v_dot2_f32_bf16 v48, v24, v54, v48
    v_dot2_f32_bf16 v49, v24, v55, v49
    v_dot2_f32_bf16 v50, v25, v54, v50
    v_dot2_f32_bf16 v51, v25, v55, v51
    v_dot2_f32_bf16 v48, v28, v54, v48
    v_dot2_f32_bf16 v49, v28, v55, v49
    v_dot2_f32_bf16 v50, v29, v54, v50
    v_dot2_f32_bf16 v51, v29, v55, v51
    v_dot2_f32_bf16 v48, v32, v54, v48
    v_dot2_f32_bf16 v49, v32, v55, v49
    v_dot2_f32_bf16 v50, v33, v54, v50
    v_dot2_f32_bf16 v51, v33, v55, v51
    v_dot2_f32_bf16 v48, v36, v54, v48
    v_dot2_f32_bf16 v49, v36, v55, v49
    v_dot2_f32_bf16 v50, v37, v54, v50
    v_dot2_f32_bf16 v51, v37, v55, v51
    v_dot2_f32_bf16 v48, v40, v54, v48
    v_dot2_f32_bf16 v49, v40, v55, v49
    v_dot2_f32_bf16 v50, v41, v54, v50
    v_dot2_f32_bf16 v51, v41, v55, v51
    v_dot2_f32_bf16 v48, v44, v54, v48
    v_dot2_f32_bf16 v49, v44, v55, v49
    v_dot2_f32_bf16 v50, v45, v54, v50
    v_dot2_f32_bf16 v51, v45, v55, v51
    s_nop 0
    v_cvt_pk_bf16_f32 v16, v48, v49
    s_nop 0
    v_cvt_pk_bf16_f32 v17, v50, v51
    s_mov_b32 exec_lo, 0x0
    s_mov_b32 exec_hi, 0x30000
    v_mov_b32 v16, 0
    v_mov_b32 v17, 0
    s_mov_b32 exec_lo, 0xffffffff
    s_mov_b32 exec_hi, 0x3ffff
    ds_write_b64 v53, v[16:17] offset:128
    s_mov_b64 exec, 1
    v_mov_b32 v14, 576
    v_mov_b32 v15, 1
    s_waitcnt lgkmcnt(0)
    ds_add_u32 v14, v15 offset:4
    s_mov_b64 exec, -1
    s_setprio 2
    buffer_load_dwordx4 a[144:147], v61, s[24:27], s64 offen offset:0 nt
    s_nop 0
    buffer_load_dwordx4 a[148:151], v61, s[24:27], s64 offen offset:1536 nt
    s_nop 0
    buffer_load_dwordx4 a[152:155], v61, s[24:27], s64 offen offset:256 nt
    s_nop 0
    buffer_load_dwordx4 a[156:159], v61, s[24:27], s64 offen offset:1792 nt
    s_nop 0
    buffer_load_dwordx4 a[160:163], v61, s[24:27], s64 offen offset:512 nt
    s_nop 0
    buffer_load_dwordx4 a[164:167], v61, s[24:27], s64 offen offset:2048 nt
    s_nop 0
    buffer_load_dwordx4 a[168:171], v61, s[24:27], s65 offen offset:0 nt
    s_nop 0
    buffer_load_dwordx4 a[172:175], v61, s[24:27], s65 offen offset:1536 nt
    s_nop 0
    buffer_load_dwordx4 a[176:179], v61, s[24:27], s65 offen offset:256 nt
    s_nop 0
    buffer_load_dwordx4 a[180:183], v61, s[24:27], s65 offen offset:1792 nt
    s_nop 0
    buffer_load_dwordx4 a[184:187], v61, s[24:27], s65 offen offset:512 nt
    s_nop 0
    buffer_load_dwordx4 a[188:191], v61, s[24:27], s65 offen offset:2048 nt
    s_nop 0
    s_setprio 0
    s_branch L_kvdone
L_ctl:
    s_setprio 3
    s_and_b32 s7, s5, 7
    s_lshl_b32 s11, s62, 2
    s_add_u32 s11, s11, s72
    s_and_b32 s60, s3, 1
    s_lshr_b32 s61, s3, 1
    s_mov_b32 s74, 0x80000000
    s_mov_b32 s10, 0x100000
    s_mov_b32 s8, 0
    s_mov_b32 s9, 0
    s_mov_b32 s73, 0x3dd53b95
    s_mul_i32 s58, s4, 27136
    s_lshl_b32 s59, s5, 12
    s_add_u32 s59, s59, 217088
    s_mov_b32 s12, s56
    s_mov_b32 s13, s57
    s_mov_b32 s14, 2689152
    s_mov_b32 s15, 0x20000
    v_lshl_add_u32 v2, v8, 3, v11
    v_lshlrev_b32 v2, 5, v2
    v_lshl_add_u32 v2, v10, 3, v2
    v_lshlrev_b32 v3, 4, v0
    v_mov_b32 v13, s74
    v_cmp_gt_u32 vcc, 4, v9
    v_lshlrev_b32 v1, 6, v8
    v_lshl_add_u32 v1, v9, 4, v1
    v_cndmask_b32 v1, v13, v1, vcc
    s_mov_b32 s28, s32
    s_mov_b32 s29, s33
    s_mov_b32 s30, 5120
    s_mov_b32 s31, 0x20000
    s_mul_i32 s69, s7, 160
    v_mul_u32_u24 v59, 1280, v9
    v_lshl_add_u32 v59, v8, 4, v59
    v_cndmask_b32 v59, v13, v59, vcc
    v_cmp_gt_u32 vcc, 32, v0
    s_nop 1
    v_cndmask_b32 v55, v13, v59, vcc
    v_mul_u32_u24 v40, 1280, v8
    v_lshl_add_u32 v40, v9, 4, v40
    buffer_load_dwordx4 v[8:11], v40, s[28:31], 0 offen offset:0
    buffer_load_dwordx4 v[12:15], v40, s[28:31], 0 offen offset:256
    buffer_load_dwordx4 v[16:19], v40, s[28:31], 0 offen offset:512
    buffer_load_dwordx4 v[20:23], v40, s[28:31], 0 offen offset:768
    buffer_load_dwordx4 v[24:27], v40, s[28:31], 0 offen offset:1024
    v_mov_b32 v62, 2689024
    buffer_load_dwordx2 v[62:63], v62, s[12:15], 0 offen sc1
    buffer_load_dwordx4 v[44:47], v59, s[28:31], s69 offen offset:0
    buffer_load_dwordx4 v[48:51], v59, s[28:31], s69 offen offset:64
    buffer_load_dwordx4 v[52:55], v55, s[28:31], s69 offen offset:128
    v_lshrrev_b32 v40, 4, v0
    v_bfe_u32 v41, v0, 3, 1
    v_and_b32 v42, 7, v0
    v_lshlrev_b32 v42, 3, v42
    v_lshl_add_u32 v42, v41, 2, v42
    v_mul_u32_u24 v40, 1280, v40
    v_add_u32 v40, v40, v42
    s_lshl_b32 s70, s5, 6
    buffer_load_dword v4, v40, s[28:31], s70 offen
    s_mov_b32 s16, s44
    s_mov_b32 s17, s45
    s_mov_b32 s18, 1280
    s_mov_b32 s19, 0x20000
    buffer_load_dword v5, v42, s[16:19], s70 offen
    v_mov_b32 v40, 0x3f803f80
    s_waitcnt vmcnt(5)
    v_dot2_f32_bf16 v28, v8, v40, 0
    v_dot2_f32_bf16 v29, v8, v8, 0
    v_dot2_f32_bf16 v28, v9, v40, v28
    v_dot2_f32_bf16 v29, v9, v9, v29
    v_dot2_f32_bf16 v28, v10, v40, v28
    v_dot2_f32_bf16 v29, v10, v10, v29
    v_dot2_f32_bf16 v28, v11, v40, v28
    v_dot2_f32_bf16 v29, v11, v11, v29
    v_dot2_f32_bf16 v28, v12, v40, v28
    v_dot2_f32_bf16 v29, v12, v12, v29
    v_dot2_f32_bf16 v28, v13, v40, v28
    v_dot2_f32_bf16 v29, v13, v13, v29
    v_dot2_f32_bf16 v28, v14, v40, v28
    v_dot2_f32_bf16 v29, v14, v14, v29
    v_dot2_f32_bf16 v28, v15, v40, v28
    v_dot2_f32_bf16 v29, v15, v15, v29
    v_dot2_f32_bf16 v28, v16, v40, v28
    v_dot2_f32_bf16 v29, v16, v16, v29
    v_dot2_f32_bf16 v28, v17, v40, v28
    v_dot2_f32_bf16 v29, v17, v17, v29
    v_dot2_f32_bf16 v28, v18, v40, v28
    v_dot2_f32_bf16 v29, v18, v18, v29
    v_dot2_f32_bf16 v28, v19, v40, v28
    v_dot2_f32_bf16 v29, v19, v19, v29
    v_dot2_f32_bf16 v28, v20, v40, v28
    v_dot2_f32_bf16 v29, v20, v20, v29
    v_dot2_f32_bf16 v28, v21, v40, v28
    v_dot2_f32_bf16 v29, v21, v21, v29
    v_dot2_f32_bf16 v28, v22, v40, v28
    v_dot2_f32_bf16 v29, v22, v22, v29
    v_dot2_f32_bf16 v28, v23, v40, v28
    v_dot2_f32_bf16 v29, v23, v23, v29
    v_dot2_f32_bf16 v28, v24, v40, v28
    v_dot2_f32_bf16 v29, v24, v24, v29
    v_dot2_f32_bf16 v28, v25, v40, v28
    v_dot2_f32_bf16 v29, v25, v25, v29
    v_dot2_f32_bf16 v28, v26, v40, v28
    v_dot2_f32_bf16 v29, v26, v26, v29
    v_dot2_f32_bf16 v28, v27, v40, v28
    v_dot2_f32_bf16 v29, v27, v27, v29
    s_nop 1
    v_add_f32_dpp v28, v28, v28 row_ror:8 row_mask:0xf bank_mask:0xf
    v_add_f32_dpp v29, v29, v29 row_ror:8 row_mask:0xf bank_mask:0xf
    s_nop 0
    v_add_f32_dpp v28, v28, v28 row_ror:4 row_mask:0xf bank_mask:0xf
    v_add_f32_dpp v29, v29, v29 row_ror:4 row_mask:0xf bank_mask:0xf
    s_nop 0
    v_add_f32_dpp v28, v28, v28 row_ror:2 row_mask:0xf bank_mask:0xf
    v_add_f32_dpp v29, v29, v29 row_ror:2 row_mask:0xf bank_mask:0xf
    s_nop 0
    v_add_f32_dpp v28, v28, v28 row_ror:1 row_mask:0xf bank_mask:0xf
    v_add_f32_dpp v29, v29, v29 row_ror:1 row_mask:0xf bank_mask:0xf
    v_mul_f32 v28, 0x3acccccd, v28
    v_mul_f32 v29, 0x3acccccd, v29
    v_fma_f32 v30, -v28, v28, v29
    v_max_f32 v30, 0, v30
    v_add_f32 v30, 0x3727c5ac, v30
    v_rsq_f32 v29, v30
    v_readfirstlane_b32 s66, v62
    v_readfirstlane_b32 s67, v63
    s_mul_i32 s42, s66, 0x9e3779b1
    s_add_u32 s42, s42, 0x7f4a7c15
    s_xor_b32 s67, s67, s42
    s_mul_i32 s43, s67, 0x85ebca6b
    s_add_u32 s43, s43, 0xc2b2ae35
    v_and_b32 v30, 3, v0
    v_lshlrev_b32 v30, 6, v30
    ds_bpermute_b32 v56, v30, v28
    ds_bpermute_b32 v57, v30, v29
    v_mov_b32 v30, s42
    v_mov_b32 v31, s43
    v_mov_b32 v32, 592
    ds_write_b64 v32, v[30:31]
    s_mov_b64 exec, 1
    v_mov_b32 v30, 576
    v_mov_b32 v31, 1
    s_waitcnt lgkmcnt(0)
    ds_add_u32 v30, v31 offset:8
    s_mov_b64 exec, -1
    v_and_b32 v62, 15, v0
    v_mul_u32_u24 v62, 384, v62
    v_lshrrev_b32 v63, 4, v0
    v_lshl_add_u32 v62, v63, 3, v62
    v_lshlrev_b32 v63, 4, v63
    v_cmp_gt_u32 vcc, 32, v0
    s_nop 1
    v_cndmask_b32 v29, 0, v40, vcc
    v_accvgpr_write_b32 a120, v40
    v_accvgpr_write_b32 a124, v29
    v_accvgpr_write_b32 a121, v40
    v_accvgpr_write_b32 a125, v29
    v_accvgpr_write_b32 a122, v40
    v_accvgpr_write_b32 a126, v29
    v_accvgpr_write_b32 a123, v40
    v_accvgpr_write_b32 a127, v29
    v_lshrrev_b32 v58, 4, v0
    v_lshlrev_b32 v58, 3, v58
    v_bfe_u32 v59, v0, 2, 2
    v_add_u32 v58, v58, v59
    v_mul_u32_u24 v58, 384, v58
    v_and_b32 v59, 3, v0
    v_lshl_add_u32 v58, v59, 3, v58
    v_add_u32 v58, 33152, v58
    v_lshrrev_b32 v59, 5, v0
    v_mul_u32_u24 v59, 6144, v59
    v_sub_u32 v59, v58, v59
    v_mov_b32 v30, 576
L_retry17:
    s_sub_u32 s10, s10, 1
    s_cbranch_scc1 L_give19
    s_sleep 1
    ds_read_b32 v31, v30 offset:0
    s_waitcnt lgkmcnt(0)
    v_cmp_ne_u32 vcc, 4, v31
    s_cbranch_vccnz L_retry17
L_ok18:
    s_lshl_b32 s68, s4, 8
    s_add_u32 s68, s68, 2686976
    v_and_b32 v6, 31, v0
    v_lshlrev_b32 v6, 3, v6
    s_mov_b32 s69, 0
    s_waitcnt vmcnt(0)
L_q1loop:
    s_cmp_eq_u32 s69, 3
    s_cbranch_scc0 L_nolook
    buffer_load_dwordx2 v[6:7], v6, s[12:15], s68 offen sc1
L_nolook:
    ds_read_b64_tr_b16 v[8:9], v58 offset:0
    ds_read_b64_tr_b16 v[10:11], v58 offset:1536
    ds_read_b64_tr_b16 v[12:13], v58 offset:12288
    ds_read_b64_tr_b16 v[14:15], v58 offset:13824
    ds_read_b64_tr_b16 v[16:17], v59 offset:24576
    ds_read_b64_tr_b16 v[18:19], v59 offset:26112
    ds_read_b64_tr_b16 v[20:21], v58 offset:32
    ds_read_b64_tr_b16 v[22:23], v58 offset:1568
    ds_read_b64_tr_b16 v[24:25], v58 offset:12320
    ds_read_b64_tr_b16 v[26:27], v58 offset:13856
    ds_read_b64_tr_b16 v[28:29], v59 offset:24608
    ds_read_b64_tr_b16 v[30:31], v59 offset:26144
    ds_read_b64_tr_b16 v[32:33], v58 offset:64
    ds_read_b64_tr_b16 v[34:35], v58 offset:1600
    ds_read_b64_tr_b16 v[36:37], v58 offset:12352
    ds_read_b64_tr_b16 v[38:39], v58 offset:13888
    ds_read_b64_tr_b16 v[40:41], v59 offset:24640
    ds_read_b64_tr_b16 v[42:43], v59 offset:26176
    s_waitcnt lgkmcnt(0)
    v_mfma_f32_16x16x32_bf16 a[96:99], v[8:11], v[44:47], 0
    v_mfma_f32_16x16x32_bf16 a[96:99], v[12:15], v[48:51], a[96:99]
    v_mfma_f32_16x16x32_bf16 a[96:99], v[16:19], v[52:55], a[96:99]
    v_mfma_f32_16x16x32_bf16 a[100:103], v[20:23], v[44:47], 0
    v_mfma_f32_16x16x32_bf16 a[100:103], v[24:27], v[48:51], a[100:103]
    v_mfma_f32_16x16x32_bf16 a[100:103], v[28:31], v[52:55], a[100:103]
    v_mfma_f32_16x16x32_bf16 a[104:107], v[32:35], v[44:47], 0
    v_mfma_f32_16x16x32_bf16 a[104:107], v[36:39], v[48:51], a[104:107]
    v_mfma_f32_16x16x32_bf16 a[104:107], v[40:43], v[52:55], a[104:107]
    v_mfma_f32_16x16x32_bf16 a[108:111], v[8:11], a[120:123], 0
    v_mfma_f32_16x16x32_bf16 a[108:111], v[12:15], a[120:123], a[108:111]
    v_mfma_f32_16x16x32_bf16 a[108:111], v[16:19], a[124:127], a[108:111]
    v_mfma_f32_16x16x32_bf16 a[112:115], v[20:23], a[120:123], 0
    v_mfma_f32_16x16x32_bf16 a[112:115], v[24:27], a[120:123], a[112:115]
    v_mfma_f32_16x16x32_bf16 a[112:115], v[28:31], a[124:127], a[112:115]
    v_mfma_f32_16x16x32_bf16 a[116:119], v[32:35], a[120:123], 0
    v_mfma_f32_16x16x32_bf16 a[116:119], v[36:39], a[120:123], a[116:119]
    v_mfma_f32_16x16x32_bf16 a[116:119], v[40:43], a[124:127], a[116:119]
    v_accvgpr_read_b32 v8, a96
    s_nop 0
    v_accvgpr_read_b32 v12, a108
    v_accvgpr_read_b32 v9, a97
    v_accvgpr_read_b32 v13, a109
    v_accvgpr_read_b32 v10, a98
    v_accvgpr_read_b32 v14, a110
    v_accvgpr_read_b32 v11, a99
    v_accvgpr_read_b32 v15, a111
    s_mov_b32 exec_lo, 0x10001
    s_mov_b32 exec_hi, 0x10001
    ds_write_b128 v63, v[12:15] offset:640
    s_mov_b32 exec_lo, 0xf000f
    s_mov_b32 exec_hi, 0xf000f
    v_fma_f32 v8, -v56, v12, v8
    v_fma_f32 v9, -v56, v13, v9
    v_fma_f32 v10, -v56, v14, v10
    v_fma_f32 v11, -v56, v15, v11
    v_mul_f32 v8, v8, v57
    v_mul_f32 v9, v9, v57
    v_mul_f32 v10, v10, v57
    v_mul_f32 v11, v11, v57
    v_cvt_pk_bf16_f32 v16, v8, v9
    v_cvt_pk_bf16_f32 v17, v10, v11
    ds_write_b64 v62, v[16:17] offset:1408
    s_mov_b64 exec, -1
    v_accvgpr_read_b32 v8, a100
    v_accvgpr_read_b32 v12, a112
    v_accvgpr_read_b32 v9, a101
    v_accvgpr_read_b32 v13, a113
    v_accvgpr_read_b32 v10, a102
    v_accvgpr_read_b32 v14, a114
    v_accvgpr_read_b32 v11, a103
    v_accvgpr_read_b32 v15, a115
    s_mov_b32 exec_lo, 0x10001
    s_mov_b32 exec_hi, 0x10001
    ds_write_b128 v63, v[12:15] offset:704
    s_mov_b32 exec_lo, 0xf000f
    s_mov_b32 exec_hi, 0xf000f
    v_fma_f32 v8, -v56, v12, v8
    v_fma_f32 v9, -v56, v13, v9
    v_fma_f32 v10, -v56, v14, v10
    v_fma_f32 v11, -v56, v15, v11
    v_mul_f32 v8, v8, v57
    v_mul_f32 v9, v9, v57
    v_mul_f32 v10, v10, v57
    v_mul_f32 v11, v11, v57
    v_cvt_pk_bf16_f32 v16, v8, v9
    v_cvt_pk_bf16_f32 v17, v10, v11
    ds_write_b64 v62, v[16:17] offset:1440
    s_mov_b64 exec, -1
    v_accvgpr_read_b32 v8, a104
    v_accvgpr_read_b32 v12, a116
    v_accvgpr_read_b32 v9, a105
    v_accvgpr_read_b32 v13, a117
    v_accvgpr_read_b32 v10, a106
    v_accvgpr_read_b32 v14, a118
    v_accvgpr_read_b32 v11, a107
    v_accvgpr_read_b32 v15, a119
    s_mov_b32 exec_lo, 0x10001
    s_mov_b32 exec_hi, 0x10001
    ds_write_b128 v63, v[12:15] offset:768
    s_mov_b32 exec_lo, 0xf000f
    s_mov_b32 exec_hi, 0xf000f
    v_fma_f32 v8, -v56, v12, v8
    v_fma_f32 v9, -v56, v13, v9
    v_fma_f32 v10, -v56, v14, v10
    v_fma_f32 v11, -v56, v15, v11
    v_mul_f32 v8, v8, v57
    v_mul_f32 v9, v9, v57
    v_mul_f32 v10, v10, v57
    v_mul_f32 v11, v11, v57
    v_cvt_pk_bf16_f32 v16, v8, v9
    v_cvt_pk_bf16_f32 v17, v10, v11
    ds_write_b64 v62, v[16:17] offset:1472
    s_mov_b64 exec, -1
    v_add_u32 v63, 192, v63
    v_add_u32 v62, 96, v62
    v_add_u32 v58, 96, v58
    v_add_u32 v59, 96, v59
    s_add_u32 s69, s69, 1
    s_cmp_lt_u32 s69, 4
    s_cbranch_scc1 L_q1loop
    v_lshlrev_b32 v28, 3, v0
    s_mul_i32 s70, s4, 98304
    s_mul_i32 s71, s6, 24576
    s_add_u32 s70, s70, s71
    s_mul_i32 s71, s7, 768
    s_add_u32 s70, s70, s71
    s_add_u32 s70, s70, 1507328
    s_waitcnt lgkmcnt(0)
    ds_read_b64 v[8:9], v28 offset:1408
    ds_read_b64 v[12:13], v28 offset:1920
    ds_read_b64 v[16:17], v28 offset:2432
    v_add_u32 v29, 0, v0
    v_mul_u32_u24 v30, 1366, v29
    v_lshrrev_b32 v30, 16, v30
    v_mul_u32_u24 v30, 5376, v30
    v_lshl_add_u32 v32, v29, 4, v30
    v_add_u32 v29, 64, v0
    v_mul_u32_u24 v30, 1366, v29
    v_lshrrev_b32 v30, 16, v30
    v_mul_u32_u24 v30, 5376, v30
    v_lshl_add_u32 v33, v29, 4, v30
    v_add_u32 v29, 128, v0
    v_mul_u32_u24 v30, 1366, v29
    v_lshrrev_b32 v30, 16, v30
    v_mul_u32_u24 v30, 5376, v30
    v_lshl_add_u32 v34, v29, 4, v30
    v_mov_b32 v10, s42
    v_mov_b32 v11, s43
    v_mov_b32 v14, s42
    v_mov_b32 v15, s43
    v_mov_b32 v18, s42
    v_mov_b32 v19, s43
    s_waitcnt lgkmcnt(0)
    s_getreg_b32 s67, hwreg(HW_REG_XCC_ID, 0, 4)
    s_add_u32 s67, s67, s43
    s_waitcnt vmcnt(0)
    v_xor_b32 v6, s42, v6
    v_xor_b32 v7, s67, v7
    v_or_b32 v6, v6, v7
    v_cmp_ne_u32 vcc, 0, v6
    s_cmp_lg_u64 vcc, 0
    s_cbranch_scc1 L_slow20
    buffer_store_dwordx4 v[8:11], v32, s[12:15], s70 offen
    buffer_store_dwordx4 v[12:15], v33, s[12:15], s70 offen
    buffer_store_dwordx4 v[16:19], v34, s[12:15], s70 offen
L_back21:
    s_mov_b64 exec, 1
    v_mov_b32 v30, 576
    v_mov_b32 v31, 1
    ds_add_u32 v30, v31 offset:8
    s_mov_b64 exec, -1
    s_setprio 1
    buffer_load_dwordx4 a[24:27], v60, s[20:23], s63 offen offset:0 nt
    s_nop 0
    buffer_load_dwordx4 a[28:31], v60, s[20:23], s63 offen offset:256 nt
    s_nop 0
    buffer_load_dwordx4 a[32:35], v60, s[20:23], s63 offen offset:512 nt
    s_nop 0
    buffer_load_dwordx4 a[36:39], v60, s[20:23], s63 offen offset:3072 nt
    s_nop 0
    buffer_load_dwordx4 a[40:43], v60, s[20:23], s63 offen offset:3328 nt
    s_nop 0
    buffer_load_dwordx4 a[44:47], v60, s[20:23], s63 offen offset:3584 nt
    s_nop 0
    buffer_load_dwordx4 a[48:51], v60, s[20:23], s64 offen offset:0 nt
    s_nop 0
    buffer_load_dwordx4 a[52:55], v60, s[20:23], s64 offen offset:256 nt
    s_nop 0
    buffer_load_dwordx4 a[56:59], v60, s[20:23], s64 offen offset:512 nt
    s_nop 0
    buffer_load_dwordx4 a[60:63], v60, s[20:23], s64 offen offset:3072 nt
    s_nop 0
    buffer_load_dwordx4 a[64:67], v60, s[20:23], s64 offen offset:3328 nt
    s_nop 0
    buffer_load_dwordx4 a[68:71], v60, s[20:23], s64 offen offset:3584 nt
    s_nop 0
    buffer_load_dwordx4 a[72:75], v60, s[20:23], s65 offen offset:0 nt
    s_nop 0
    buffer_load_dwordx4 a[76:79], v60, s[20:23], s65 offen offset:256 nt
    s_nop 0
    buffer_load_dwordx4 a[80:83], v60, s[20:23], s65 offen offset:512 nt
    s_nop 0
    buffer_load_dwordx4 a[84:87], v60, s[20:23], s65 offen offset:3072 nt
    s_nop 0
    buffer_load_dwordx4 a[88:91], v60, s[20:23], s65 offen offset:3328 nt
    s_nop 0
    buffer_load_dwordx4 a[92:95], v60, s[20:23], s65 offen offset:3584 nt
    s_nop 0
    buffer_load_dwordx4 a[96:99], v61, s[24:27], 0 offen offset:0 nt
    s_nop 0
    buffer_load_dwordx4 a[100:103], v61, s[24:27], 0 offen offset:1536 nt
    s_nop 0
    buffer_load_dwordx4 a[104:107], v61, s[24:27], 0 offen offset:256 nt
    s_nop 0
    buffer_load_dwordx4 a[108:111], v61, s[24:27], 0 offen offset:1792 nt
    s_nop 0
    buffer_load_dwordx4 a[112:115], v61, s[24:27], 0 offen offset:512 nt
    s_nop 0
    buffer_load_dwordx4 a[116:119], v61, s[24:27], 0 offen offset:2048 nt
    s_nop 0
    buffer_load_dwordx4 a[120:123], v61, s[24:27], s63 offen offset:0 nt
    s_nop 0
    buffer_load_dwordx4 a[124:127], v61, s[24:27], s63 offen offset:1536 nt
    s_nop 0
    buffer_load_dwordx4 a[128:131], v61, s[24:27], s63 offen offset:256 nt
    s_nop 0
    buffer_load_dwordx4 a[132:135], v61, s[24:27], s63 offen offset:1792 nt
    s_nop 0
    buffer_load_dwordx4 a[136:139], v61, s[24:27], s63 offen offset:512 nt
    s_nop 0
    buffer_load_dwordx4 a[140:143], v61, s[24:27], s63 offen offset:2048 nt
    s_nop 0
    buffer_load_dwordx4 a[144:147], v61, s[24:27], s64 offen offset:0 nt
    s_nop 0
    buffer_load_dwordx4 a[148:151], v61, s[24:27], s64 offen offset:1536 nt
    s_nop 0
    buffer_load_dwordx4 a[152:155], v61, s[24:27], s64 offen offset:256 nt
    s_nop 0
    buffer_load_dwordx4 a[156:159], v61, s[24:27], s64 offen offset:1792 nt
    s_nop 0
    buffer_load_dwordx4 a[160:163], v61, s[24:27], s64 offen offset:512 nt
    s_nop 0
    buffer_load_dwordx4 a[164:167], v61, s[24:27], s64 offen offset:2048 nt
    s_nop 0
    buffer_load_dwordx4 a[168:171], v61, s[24:27], s65 offen offset:0 nt
    s_nop 0
    buffer_load_dwordx4 a[172:175], v61, s[24:27], s65 offen offset:1536 nt
    s_nop 0
    buffer_load_dwordx4 a[176:179], v61, s[24:27], s65 offen offset:256 nt
    s_nop 0
    buffer_load_dwordx4 a[180:183], v61, s[24:27], s65 offen offset:1792 nt
    s_nop 0
    buffer_load_dwordx4 a[184:187], v61, s[24:27], s65 offen offset:512 nt
    s_nop 0
    buffer_load_dwordx4 a[188:191], v61, s[24:27], s65 offen offset:2048 nt
    s_nop 0
L_kvcount:
    s_mov_b64 exec, 1
    v_mov_b32 v14, 576
    v_mov_b32 v15, 1
    ds_add_u32 v14, v15 offset:12
    s_mov_b64 exec, -1
L_kvdone:
    v_mov_b32 v14, 576
L_retry22:
    s_sub_u32 s10, s10, 1
    s_cbranch_scc1 L_give24
    s_sleep 1
    ds_read_b32 v15, v14 offset:4
    s_waitcnt lgkmcnt(0)
    v_cmp_ne_u32 vcc, 2, v15
    s_cbranch_vccnz L_retry22
L_ok23:
    s_cmp_lt_u32 s5, 20
    s_cbranch_scc0 L_lsg25
    s_and_b32 s30, s5, 1
    s_mul_i32 s30, s30, 3
    s_mul_i32 s28, s4, 983040
    s_lshl_b32 s71, s5, 6
    s_add_u32 s28, s28, s71
    s_mul_i32 s71, s3, 122880
    s_add_u32 s28, s28, s71
    s_mul_i32 s29, s3, 6144
    s_add_u32 s29, s29, 63872
    s_mov_b32 s16, s40
    s_mov_b32 s17, s41
    s_mov_b32 s18, 7864320
    s_mov_b32 s19, 0x20000
    s_branch L_lse26
L_lsg25:
    s_cmp_eq_u32 s60, 0
    s_cselect_b32 s16, s46, s48
    s_cselect_b32 s17, s47, s49
    s_mov_b32 s18, 1966080
    s_mov_b32 s19, 0x20000
    s_mul_i32 s28, s4, 384
    s_lshl_b32 s71, s5, 5
    s_add_u32 s28, s28, s71
    s_mul_i32 s71, s61, 491520
    s_add_u32 s28, s28, s71
    s_add_u32 s28, s28, 4294966656
    s_mul_i32 s29, s3, 5120
    s_add_u32 s29, s29, 63872
    s_and_b32 s30, s5, 3
    s_mul_i32 s31, s4, 98304
    s_lshl_b32 s71, s5, 13
    s_add_u32 s31, s31, s71
    s_lshl_b32 s71, s3, 10
    s_add_u32 s31, s31, s71
    s_add_u32 s31, s31, 557056
L_lse26:
    ds_read_b128 v[32:35], v3 offset:9600
    ds_read_b128 v[36:39], v3 offset:10624
    ds_read_b128 v[60:63], v3 offset:11648
    v_mov_b64 v[48:49], 0
    v_mov_b64 v[50:51], 0
    v_mov_b64 v[52:53], 0
    v_mov_b64 v[54:55], 0
    v_mov_b64 v[56:57], 0
    v_mov_b64 v[58:59], 0
    s_mul_i32 s67, s3, 1664
    s_mul_i32 s63, s3, 6144
    s_mul_i32 s20, s6, 3072
    s_mul_i32 s71, s3, 384
    s_add_u32 s20, s20, s71
    s_lshl_b32 s71, s11, 4
    s_add_u32 s20, s20, s71
    s_add_u32 s20, s20, s58
    s_lshl_b32 s21, s6, 6
    s_lshl_b32 s71, s11, 3
    s_add_u32 s21, s21, s71
    s_add_u32 s21, s21, s58
    s_add_u32 s21, s21, 12288
    s_lshl_b32 s22, s3, 4
    s_mul_i32 s23, s3, 96
    s_mul_i32 s24, s3, 1536
    s_add_u32 s24, s24, s58
    s_lshl_b32 s25, s61, 6
    s_add_u32 s25, s25, s58
    s_add_u32 s25, s25, 12288
    s_lshl_b32 s26, s3, 9
    s_lshl_b32 s27, s4, 9
    s_add_u32 s27, s27, s59
    s_lshl_b32 s75, s8, 4
    s_add_u32 s75, s75, s3
    s_add_u32 s75, s75, 4294967295
    v_mov_b32 v7, s73
    s_waitcnt lgkmcnt(0)
    v_add_u32 v63, s63, v63
    s_setprio 2
    ds_read_b128 v[8:11], v32
    ds_read_b128 v[12:15], v33
    ds_read_b128 v[16:19], v34
    ds_read_b128 v[20:23], v35
    ds_read_b128 v[24:27], v36
    ds_read_b128 v[28:31], v37
L_att:
    s_waitcnt vmcnt(42)
    s_waitcnt lgkmcnt(5)
    v_mfma_f32_16x16x32_bf16 v[32:35], a[0:3], v[8:11], 0
    s_waitcnt lgkmcnt(4)
    v_mfma_f32_16x16x32_bf16 v[32:35], a[4:7], v[12:15], v[32:35]
    s_waitcnt lgkmcnt(3)
    v_mfma_f32_16x16x32_bf16 v[32:35], a[8:11], v[16:19], v[32:35]
    s_waitcnt lgkmcnt(2)
    v_mfma_f32_16x16x32_bf16 v[32:35], a[12:15], v[20:23], v[32:35]
    s_waitcnt lgkmcnt(1)
    v_mfma_f32_16x16x32_bf16 v[32:35], a[16:19], v[24:27], v[32:35]
    s_waitcnt lgkmcnt(0)
    v_mfma_f32_16x16x32_bf16 v[32:35], a[20:23], v[28:31], v[32:35]
    s_waitcnt vmcnt(36)
    v_mfma_f32_16x16x32_bf16 v[36:39], a[24:27], v[8:11], 0
    v_mfma_f32_16x16x32_bf16 v[36:39], a[28:31], v[12:15], v[36:39]
    v_mfma_f32_16x16x32_bf16 v[36:39], a[32:35], v[16:19], v[36:39]
    v_mfma_f32_16x16x32_bf16 v[36:39], a[36:39], v[20:23], v[36:39]
    v_mfma_f32_16x16x32_bf16 v[36:39], a[40:43], v[24:27], v[36:39]
    v_mfma_f32_16x16x32_bf16 v[36:39], a[44:47], v[28:31], v[36:39]
    s_waitcnt vmcnt(30)
    v_mfma_f32_16x16x32_bf16 v[40:43], a[48:51], v[8:11], 0
    v_mfma_f32_16x16x32_bf16 v[40:43], a[52:55], v[12:15], v[40:43]
    v_mul_f32_dpp v32, v32, v7 quad_perm:[0,0,0,0] row_mask:0xf bank_mask:0xf
    v_mfma_f32_16x16x32_bf16 v[40:43], a[56:59], v[16:19], v[40:43]
    v_mfma_f32_16x16x32_bf16 v[40:43], a[60:63], v[20:23], v[40:43]
    v_fmac_f32_dpp v32, v33, v7 quad_perm:[1,1,1,1] row_mask:0xf bank_mask:0xf
    v_mfma_f32_16x16x32_bf16 v[40:43], a[64:67], v[24:27], v[40:43]
    v_mfma_f32_16x16x32_bf16 v[40:43], a[68:71], v[28:31], v[40:43]
    v_fmac_f32_dpp v32, v34, v7 quad_perm:[2,2,2,2] row_mask:0xf bank_mask:0xf
    s_waitcnt vmcnt(24)
    v_mfma_f32_16x16x32_bf16 v[44:47], a[72:75], v[8:11], 0
    v_fmac_f32_dpp v32, v35, v7 quad_perm:[3,3,3,3] row_mask:0xf bank_mask:0xf
    v_mul_f32_dpp v36, v36, v7 quad_perm:[0,0,0,0] row_mask:0xf bank_mask:0xf
    v_mfma_f32_16x16x32_bf16 v[44:47], a[76:79], v[12:15], v[44:47]
    v_mfma_f32_16x16x32_bf16 v[44:47], a[80:83], v[16:19], v[44:47]
    v_fmac_f32_dpp v36, v37, v7 quad_perm:[1,1,1,1] row_mask:0xf bank_mask:0xf
    v_mfma_f32_16x16x32_bf16 v[44:47], a[84:87], v[20:23], v[44:47]
    v_mfma_f32_16x16x32_bf16 v[44:47], a[88:91], v[24:27], v[44:47]
    v_fmac_f32_dpp v36, v38, v7 quad_perm:[2,2,2,2] row_mask:0xf bank_mask:0xf
    v_mfma_f32_16x16x32_bf16 v[44:47], a[92:95], v[28:31], v[44:47]
    s_setprio 1
    v_mul_f32_dpp v40, v40, v7 quad_perm:[0,0,0,0] row_mask:0xf bank_mask:0xf
    v_fmac_f32_dpp v36, v39, v7 quad_perm:[3,3,3,3] row_mask:0xf bank_mask:0xf
    ds_read_b128 v[16:19], v3 offset:12672
    v_fmac_f32_dpp v40, v41, v7 quad_perm:[1,1,1,1] row_mask:0xf bank_mask:0xf
    v_mov_b64 v[8:9], 0
    ds_read_b128 v[24:27], v3 offset:18816
    v_mov_b64 v[10:11], 0
    v_fmac_f32_dpp v40, v42, v7 quad_perm:[2,2,2,2] row_mask:0xf bank_mask:0xf
    v_mul_f32_dpp v44, v44, v7 quad_perm:[0,0,0,0] row_mask:0xf bank_mask:0xf
    v_max_f32 v33, v32, v36
    v_fmac_f32_dpp v40, v43, v7 quad_perm:[3,3,3,3] row_mask:0xf bank_mask:0xf
    v_fmac_f32_dpp v44, v45, v7 quad_perm:[1,1,1,1] row_mask:0xf bank_mask:0xf
    v_mov_b64 v[12:13], 0
    v_mov_b64 v[14:15], 0
    v_fmac_f32_dpp v44, v46, v7 quad_perm:[2,2,2,2] row_mask:0xf bank_mask:0xf
    v_max_f32 v33, v33, v40
    s_nop 0
    v_fmac_f32_dpp v44, v47, v7 quad_perm:[3,3,3,3] row_mask:0xf bank_mask:0xf
    v_max_f32 v33, v33, v44
    s_nop 1
    v_max_f32_dpp v33, v33, v33 row_ror:4 row_mask:0xf bank_mask:0xf
    s_nop 1
    v_max_f32_dpp v33, v33, v33 row_ror:8 row_mask:0xf bank_mask:0xf
    s_nop 1
    v_max_f32_dpp v33, v33, v33 row_bcast:15 row_mask:0xa bank_mask:0xf
    s_nop 1
    v_max_f32_dpp v33, v33, v33 row_bcast:31 row_mask:0xc bank_mask:0xf
    s_nop 0
    v_readlane_b32 s66, v33, 63
    s_nop 1
    v_subrev_f32 v32, s66, v32
    v_subrev_f32 v36, s66, v36
    v_exp_f32 v32, v32
    v_exp_f32 v36, v36
    v_cvt_pk_bf16_f32 v20, v32, 0
    v_cvt_pk_bf16_f32 v21, v36, 0
    v_subrev_f32 v40, s66, v40
    v_mov_b32_dpp v8, v20 quad_perm:[0,1,2,3] row_mask:0xf bank_mask:0x5
    v_mov_b32_dpp v9, v20 row_shr:4 row_mask:0xf bank_mask:0xa
    v_mov_b32_dpp v10, v20 row_shl:4 row_mask:0xf bank_mask:0x5
    v_mov_b32_dpp v11, v20 quad_perm:[0,1,2,3] row_mask:0xf bank_mask:0xa
    s_setprio 0
    s_waitcnt vmcnt(18)
    v_smfmac_f32_16x16x64_bf16 v[48:51], v[8:11], a[96:103], v60
    v_mov_b32_dpp v12, v21 quad_perm:[0,1,2,3] row_mask:0xf bank_mask:0x5
    v_mov_b32_dpp v13, v21 row_shr:4 row_mask:0xf bank_mask:0xa
    v_smfmac_f32_16x16x64_bf16 v[52:55], v[8:11], a[104:111], v60
    v_exp_f32 v40, v40
    v_mov_b32_dpp v14, v21 row_shl:4 row_mask:0xf bank_mask:0x5
    v_smfmac_f32_16x16x64_bf16 v[56:59], v[8:11], a[112:119], v60
    v_mov_b32_dpp v15, v21 quad_perm:[0,1,2,3] row_mask:0xf bank_mask:0xa
    v_cvt_pk_bf16_f32 v22, v40, 0
    v_subrev_f32 v44, s66, v44
    s_waitcnt vmcnt(12)
    v_smfmac_f32_16x16x64_bf16 v[48:51], v[12:15], a[120:127], v60
    v_exp_f32 v44, v44
    v_mov_b32_dpp v8, v22 quad_perm:[0,1,2,3] row_mask:0xf bank_mask:0x5
    v_smfmac_f32_16x16x64_bf16 v[52:55], v[12:15], a[128:135], v60
    v_mov_b32_dpp v9, v22 row_shr:4 row_mask:0xf bank_mask:0xa
    v_cvt_pk_bf16_f32 v23, v44, 0
    v_smfmac_f32_16x16x64_bf16 v[56:59], v[12:15], a[136:143], v60
    v_mov_b32_dpp v10, v22 row_shl:4 row_mask:0xf bank_mask:0x5
    v_mov_b32_dpp v11, v22 quad_perm:[0,1,2,3] row_mask:0xf bank_mask:0xa
    v_add_f32 v35, v32, v36
    s_waitcnt vmcnt(6) lgkmcnt(0)
    v_smfmac_f32_16x16x64_bf16 v[48:51], v[8:11], a[144:151], v60
    v_add_f32 v37, v40, v44
    v_mov_b32_dpp v12, v23 quad_perm:[0,1,2,3] row_mask:0xf bank_mask:0x5
    v_smfmac_f32_16x16x64_bf16 v[52:55], v[8:11], a[152:159], v60
    v_mov_b32_dpp v13, v23 row_shr:4 row_mask:0xf bank_mask:0xa
    v_mov_b32_dpp v14, v23 row_shl:4 row_mask:0xf bank_mask:0x5
    v_mov_b32_dpp v15, v23 quad_perm:[0,1,2,3] row_mask:0xf bank_mask:0xa
    v_smfmac_f32_16x16x64_bf16 v[56:59], v[8:11], a[160:167], v60
    v_add_f32 v35, v35, v37
    v_add_u32 v24, s67, v24
    v_add_u32 v25, s67, v25
    s_waitcnt vmcnt(4)
    v_smfmac_f32_16x16x64_bf16 v[48:51], v[12:15], a[168:175], v60
    v_add_f32_dpp v35, v35, v35 row_ror:4 row_mask:0xf bank_mask:0xf
    v_mov_b32 v34, s66
    s_cmp_eq_u32 s3, 0
    s_cselect_b32 s66, 0, s74
    s_waitcnt vmcnt(2)
    v_smfmac_f32_16x16x64_bf16 v[52:55], v[12:15], a[176:183], v60
    v_add_f32_dpp v35, v35, v35 row_ror:8 row_mask:0xf bank_mask:0xf
    v_add_u32 v26, s67, v26
    s_waitcnt vmcnt(0)
    v_smfmac_f32_16x16x64_bf16 v[56:59], v[12:15], a[184:191], v60
    v_add_f32_dpp v35, v35, v35 row_bcast:15 row_mask:0xa bank_mask:0xf
    v_add_u32 v27, s22, v27
    v_add_u32 v16, s23, v16
    v_add_f32_dpp v35, v35, v35 row_bcast:31 row_mask:0xc bank_mask:0xf
    v_or_b32 v19, s66, v19
    s_cmp_lt_u32 s75, 4
    ds_write_b128 v24, v[48:51]
    ds_write_b64 v27, v[34:35] offset:0
    ds_write_b128 v25, v[52:55]
    ds_write_b128 v26, v[56:59]
    s_cbranch_scc1 L_aside27
L_ret28:
    s_cmp_lt_u32 s5, 20
    s_cbranch_scc0 L_gu
    s_waitcnt lgkmcnt(0)
    s_barrier
    ds_read_b128 v[20:23], v17 offset:0
    ds_read_b128 v[8:11], v16
    ds_read_b128 v[12:15], v16 offset:768
    ds_read_b128 v[56:59], v3 offset:13696
    s_waitcnt lgkmcnt(3)
    v_max_f32_dpp v24, v20, v20 row_ror:8 row_mask:0xf bank_mask:0xf
    v_readfirstlane_b32 s9, v22
    s_nop 0
    v_max_f32_dpp v24, v24, v24 row_bcast:15 row_mask:0xa bank_mask:0xf
    s_waitcnt lgkmcnt(1)
    v_pk_add_f32 v[8:9], v[8:9], v[12:13]
    v_max_f32_dpp v24, v24, v24 row_bcast:31 row_mask:0xc bank_mask:0xf
    v_pk_add_f32 v[10:11], v[10:11], v[14:15]
    v_readlane_b32 s66, v24, 63
    s_cmp_eq_u32 s9, 0
    s_nop 0
    v_subrev_f32 v20, s66, v20
    v_exp_f32 v20, v20
    s_nop 0
    v_mul_f32 v21, v21, v20
    v_pk_mul_f32 v[8:9], v[8:9], v[20:21] op_sel_hi:[1,0]
    v_pk_mul_f32 v[10:11], v[10:11], v[20:21] op_sel_hi:[1,0]
    v_add_f32_dpp v21, v21, v21 row_ror:8 row_mask:0xf bank_mask:0xf
    v_mov_b32 v20, s66
    v_permlane32_swap_b32 v8, v10
    v_permlane32_swap_b32 v9, v11
    v_pk_add_f32 v[8:9], v[8:9], v[10:11]
    v_add_f32_dpp v21, v21, v21 row_bcast:15 row_mask:0xa bank_mask:0xf
    s_waitcnt lgkmcnt(0)
    v_permlane16_swap_b32 v8, v9
    v_add_f32 v8, v8, v9
    v_add_f32_dpp v21, v21, v21 row_bcast:31 row_mask:0xc bank_mask:0xf
    s_nop 0
    v_add_f32_dpp v8, v8, v8 row_ror:8 row_mask:0xf bank_mask:0xf
    v_mov_b32 v9, v8
    s_nop 1
    v_permlane16_swap_b32 v9, v8
    v_cvt_pk_bf16_f32 v8, v9, v8
    s_cbranch_scc1 L_slow35
    buffer_store_dword v8, v18, s[12:15], s20 offen
    buffer_store_dwordx2 v[20:21], v19, s[12:15], s21 offen
L_back36:
    s_cmp_eq_u32 s8, 0
    s_cbranch_scc0 L_wo1
    s_barrier
    s_add_u32 s70, s30, 4
    s_sub_u32 s71, s70, 6
    s_cselect_b32 s70, s70, s71
    s_mul_i32 s71, s70, 20480
    s_lshl_b32 s70, s70, 10
    s_add_u32 m0, s70, s29
    s_add_u32 s71, s71, s28
    buffer_load_dwordx4 v59, s[16:19], s71 offen lds
    s_add_u32 s70, s30, 5
    s_sub_u32 s71, s70, 6
    s_cselect_b32 s70, s70, s71
    s_mul_i32 s71, s70, 20480
    s_lshl_b32 s70, s70, 10
    s_add_u32 m0, s70, s29
    s_add_u32 s71, s71, s28
    buffer_load_dwordx4 v59, s[16:19], s71 offen lds
    s_waitcnt vmcnt(0)
    s_barrier
L_wo1:
    ds_read_b64_tr_b16 v[32:33], v63 offset:0
    ds_read_b64_tr_b16 v[34:35], v63 offset:256
    ds_read_b64_tr_b16 v[36:37], v63 offset:2048
    ds_read_b64_tr_b16 v[38:39], v63 offset:2304
    ds_read_b64_tr_b16 v[40:41], v63 offset:4096
    ds_read_b64_tr_b16 v[42:43], v63 offset:4352
    ds_read_b64_tr_b16 v[44:45], v63 offset:32
    ds_read_b64_tr_b16 v[46:47], v63 offset:288
    ds_read_b64_tr_b16 v[48:49], v63 offset:2080
    ds_read_b64_tr_b16 v[50:51], v63 offset:2336
    ds_read_b64_tr_b16 v[52:53], v63 offset:4128
    ds_read_b64_tr_b16 v[54:55], v63 offset:4384
    v_add_u32 v58, s26, v58
    s_cmp_eq_u32 s3, 0
    s_cbranch_scc0 L_np0
    s_setprio 3
    ds_read_b128 v[60:63], v3 offset:14720
L_np0:
L_retry37:
    s_sub_u32 s10, s10, 1
    s_cbranch_scc1 L_give39
    buffer_load_dwordx2 v[28:29], v57, s[12:15], s25 offen sc1
    buffer_load_dwordx4 v[8:11], v56, s[12:15], s24 offen offset:0 sc1
    buffer_load_dwordx4 v[12:15], v56, s[12:15], s24 offen offset:512 sc1
    buffer_load_dwordx4 v[16:19], v56, s[12:15], s24 offen offset:1024 sc1
    s_waitcnt vmcnt(3)
    v_mov_b32_dpp v30, v28 row_shl:4 row_mask:0xf bank_mask:0x5
    v_mov_b32_dpp v31, v29 row_shl:4 row_mask:0xf bank_mask:0x5
    s_nop 0
    v_mov_b32_dpp v30, v28 row_shr:4 row_mask:0xf bank_mask:0xa
    v_mov_b32_dpp v31, v29 row_shr:4 row_mask:0xf bank_mask:0xa
    v_sub_f32 v30, v30, v28
    v_exp_f32 v30, v30
    s_waitcnt vmcnt(0) lgkmcnt(0)
    v_max3_u32 v7, v11, v15, v19
    v_cmp_eq_u32 vcc, -1, v7
    s_cbranch_vccnz L_retry37
    v_mfma_f32_16x16x32_bf16 v[20:23], v[32:35], v[8:11], 0
    v_fma_f32 v30, v31, v30, v29
    v_mfma_f32_16x16x32_bf16 v[20:23], v[36:39], v[12:15], v[20:23]
    v_rcp_f32 v30, v30
    v_max3_u32 v7, v28, v29, v8
    v_mfma_f32_16x16x32_bf16 v[20:23], v[40:43], v[16:19], v[20:23]
    v_max3_u32 v7, v7, v9, v10
    v_max3_u32 v7, v7, v11, v12
    v_mfma_f32_16x16x32_bf16 v[24:27], v[44:47], v[8:11], 0
    v_max3_u32 v7, v7, v13, v14
    v_mfma_f32_16x16x32_bf16 v[24:27], v[48:51], v[12:15], v[24:27]
    v_max3_u32 v7, v7, v15, v16
    v_max3_u32 v7, v7, v17, v18
    v_mfma_f32_16x16x32_bf16 v[24:27], v[52:55], v[16:19], v[24:27]
    v_max_u32 v7, v7, v19
    v_cmp_eq_u32 vcc, -1, v7
    s_cbranch_vccnz L_retry37
L_ok38:
    v_pk_mul_f32 v[20:21], v[20:21], v[30:31] op_sel_hi:[1,0]
    v_pk_mul_f32 v[22:23], v[22:23], v[30:31] op_sel_hi:[1,0]
    s_nop 0
    v_add_f32_dpp v20, v20, v20 row_shl:4 row_mask:0xf bank_mask:0x1
    v_add_f32_dpp v21, v21, v21 row_shl:4 row_mask:0xf bank_mask:0x1
    v_add_f32_dpp v22, v22, v22 row_shl:4 row_mask:0xf bank_mask:0x1
    v_add_f32_dpp v23, v23, v23 row_shl:4 row_mask:0xf bank_mask:0x1
    ds_write_b128 v58, v[20:23] offset:0
    v_pk_mul_f32 v[24:25], v[24:25], v[30:31] op_sel_hi:[1,0]
    v_pk_mul_f32 v[26:27], v[26:27], v[30:31] op_sel_hi:[1,0]
    s_cmp_eq_u32 s3, 0
    v_add_f32_dpp v24, v24, v24 row_shl:4 row_mask:0xf bank_mask:0x1
    v_add_f32_dpp v25, v25, v25 row_shl:4 row_mask:0xf bank_mask:0x1
    v_add_f32_dpp v26, v26, v26 row_shl:4 row_mask:0xf bank_mask:0x1
    v_add_f32_dpp v27, v27, v27 row_shl:4 row_mask:0xf bank_mask:0x1
    ds_write_b128 v58, v[24:27] offset:256
    s_cbranch_scc0 L_own_rest
    s_waitcnt lgkmcnt(0)
    s_barrier
    ds_read_b128 v[8:11], v60 offset:0
    ds_read_b128 v[12:15], v60 offset:512
    ds_read_b128 v[16:19], v60 offset:1024
    ds_read_b128 v[20:23], v60 offset:1536
    ds_read_b128 v[56:59], v3 offset:15744
    v_mov_b64 v[24:25], 0
    v_mov_b64 v[26:27], 0
    s_waitcnt lgkmcnt(3)
    v_pk_add_f32 v[8:9], v[8:9], v[12:13]
    v_pk_add_f32 v[10:11], v[10:11], v[14:15]
    s_waitcnt lgkmcnt(1)
    v_pk_add_f32 v[16:17], v[16:17], v[20:21]
    v_pk_add_f32 v[18:19], v[18:19], v[22:23]
    v_pk_add_f32 v[8:9], v[8:9], v[16:17]
    v_pk_add_f32 v[10:11], v[10:11], v[18:19]
    s_nop 0
    v_add_f32_dpp v24, v8, v8 row_ror:8 row_mask:0xf bank_mask:0x3
    v_add_f32_dpp v25, v9, v9 row_ror:8 row_mask:0xf bank_mask:0x3
    v_add_f32_dpp v26, v10, v10 row_ror:8 row_mask:0xf bank_mask:0x3
    v_add_f32_dpp v27, v11, v11 row_ror:8 row_mask:0xf bank_mask:0x3
    buffer_store_dwordx4 v[24:27], v61, s[12:15], s27 offen sc1
    s_lshl_b32 s63, s5, 8
    s_add_u32 s63, s63, s58
    s_add_u32 s63, s63, 12544
    s_lshl_b32 s64, s5, 6
    s_add_u32 s64, s64, s58
    s_add_u32 s64, s64, 17664
    v_lshlrev_b32 v54, 16, v4
    v_and_b32 v55, 0xffff0000, v4
    v_lshlrev_b32 v52, 16, v5
    v_and_b32 v53, 0xffff0000, v5
    s_waitcnt lgkmcnt(0)
    v_cmp_gt_u32 vcc, s74, v61
    v_mov_b32 v60, s74
    s_nop 0
    v_cndmask_b32 v60, v62, v60, vcc
    s_xor_b32 s66, s4, 0
    s_and_b32 s66, s66, 3
    s_lshl_b32 s66, s66, 9
    s_add_u32 s66, s66, s59
    s_xor_b32 s67, s4, 1
    s_and_b32 s67, s67, 3
    s_lshl_b32 s67, s67, 9
    s_add_u32 s67, s67, s59
    s_xor_b32 s68, s4, 2
    s_and_b32 s68, s68, 3
    s_lshl_b32 s68, s68, 9
    s_add_u32 s68, s68, s59
    s_xor_b32 s69, s4, 3
    s_and_b32 s69, s69, 3
    s_lshl_b32 s69, s69, 9
    s_add_u32 s69, s69, s59
    s_sleep 8
    s_or_b32 s10, s10, 31
L_nan40:
    s_sub_u32 s10, s10, 1
    s_and_b32 s71, s10, 31
    s_cbranch_scc0 L_exact43
L_retry41:
    buffer_load_dwordx4 v[32:35], v60, s[12:15], s66 offen sc1
    buffer_load_dwordx4 v[36:39], v62, s[12:15], s67 offen sc1
    buffer_load_dwordx4 v[40:43], v62, s[12:15], s68 offen sc1
    buffer_load_dwordx4 v[44:47], v62, s[12:15], s69 offen sc1
    s_cmp_eq_u32 s9, 0
    s_waitcnt vmcnt(3)
    v_pk_add_f32 v[8:9], v[32:33], v[24:25]
    v_pk_add_f32 v[10:11], v[34:35], v[26:27]
    s_waitcnt vmcnt(2)
    v_pk_add_f32 v[8:9], v[8:9], v[36:37]
    v_pk_add_f32 v[10:11], v[10:11], v[38:39]
    s_waitcnt vmcnt(1)
    v_pk_add_f32 v[8:9], v[8:9], v[40:41]
    v_pk_add_f32 v[10:11], v[10:11], v[42:43]
    s_waitcnt vmcnt(0)
    v_pk_add_f32 v[8:9], v[8:9], v[44:45]
    v_pk_add_f32 v[10:11], v[10:11], v[46:47]
    s_nop 0
    v_add_f32_dpp v48, v8, v8 row_ror:8 row_mask:0xf bank_mask:0x3
    v_add_f32_dpp v49, v9, v9 row_ror:8 row_mask:0xf bank_mask:0x3
    s_nop 0
    v_add_f32_dpp v48, v10, v10 row_ror:8 row_mask:0xf bank_mask:0xc
    v_add_f32_dpp v49, v11, v11 row_ror:8 row_mask:0xf bank_mask:0xc
    v_cmp_u_f32 vcc, v48, v49
    s_cbranch_vccnz L_nan40
L_ok42:
    v_pk_add_f32 v[48:49], v[48:49], v[54:55]
    v_cvt_pk_bf16_f32 v4, v48, v49
    s_cbranch_scc1 L_slow44
    buffer_store_dword v4, v63, s[12:15], s63 offen
L_back45:
    v_lshlrev_b32 v8, 16, v4
    v_and_b32 v9, 0xffff0000, v4
    v_add_f32 v51, v52, v53
    v_add_f32 v48, v8, v9
    v_mul_f32 v49, v8, v8
    v_mul_f32 v50, v8, v52
    v_fmac_f32 v49, v9, v9
    v_fmac_f32 v50, v9, v53
    v_add_f32_dpp v48, v48, v48 row_ror:8 row_mask:0xf bank_mask:0x3
    v_add_f32_dpp v49, v49, v49 row_ror:8 row_mask:0xf bank_mask:0x3
    s_nop 0
    v_add_f32_dpp v48, v50, v50 row_ror:8 row_mask:0xf bank_mask:0xc
    v_add_f32_dpp v49, v51, v51 row_ror:8 row_mask:0xf bank_mask:0xc
    s_nop 0
    v_add_f32_dpp v48, v48, v48 row_shl:4 row_mask:0xf bank_mask:0x5
    s_nop 1
    v_add_f32_dpp v48, v49, v49 row_shr:4 row_mask:0xf bank_mask:0xa
    s_nop 1
    v_add_f32_dpp v48, v48, v48 quad_perm:[1,0,3,2] row_mask:0xf bank_mask:0xf
    s_cmp_eq_u32 s9, 0
    s_nop 0
    v_add_f32_dpp v48, v48, v48 quad_perm:[2,3,0,1] row_mask:0xf bank_mask:0xf
    s_cbranch_scc1 L_slow46
    buffer_store_dword v48, v56, s[12:15], s64 offen
L_back47:
    s_cmp_eq_u32 s8, 0
    s_cbranch_scc0 L_nobx
    s_barrier
L_nobx:
    s_or_b32 s64, s2, s8
    s_cmp_eq_u32 s64, 0
    s_cbranch_scc0 L_notag
    v_mov_b32 v28, s42
    v_mov_b32 v29, s43
    v_mov_b32 v30, 2689024
    s_mov_b64 exec, 1
    buffer_store_dwordx2 v[28:29], v30, s[12:15], 0 offen sc1
    s_mov_b64 exec, -1
    v_mov_b64 v[8:9], 0
    v_mov_b64 v[10:11], 0
    s_mov_b32 s64, 2686976
    buffer_store_dwordx4 v[8:11], v3, s[12:15], s64 offen sc1
    buffer_store_dwordx4 v[8:11], v3, s[12:15], s64 offen offset:1024 sc1
L_notag:
    s_add_u32 s64, s58, 17664
L_retry48:
    s_sub_u32 s10, s10, 1
    s_cbranch_scc1 L_give50
    buffer_load_dwordx4 v[16:19], v58, s[12:15], s64 offen sc1
    buffer_load_dwordx4 v[20:23], v59, s[12:15], s64 offen sc1
    s_waitcnt vmcnt(0)
    v_max3_u32 v7, v16, v17, v18
    v_max3_u32 v7, v7, v19, v20
    v_max3_u32 v7, v7, v21, v22
    v_max_u32 v7, v7, v23
    v_cmp_eq_u32 vcc, -1, v7
    s_cbranch_vccnz L_retry48
L_ok49:
    v_pk_add_f32 v[16:17], v[16:17], v[20:21]
    v_pk_add_f32 v[18:19], v[18:19], v[22:23]
    s_nop 0
    v_add_f32_dpp v16, v16, v16 row_ror:8 row_mask:0xf bank_mask:0xf
    v_add_f32_dpp v17, v17, v17 row_ror:8 row_mask:0xf bank_mask:0xf
    v_add_f32_dpp v18, v18, v18 row_ror:8 row_mask:0xf bank_mask:0xf
    v_add_f32_dpp v19, v19, v19 row_ror:8 row_mask:0xf bank_mask:0xf
    v_add_f32_dpp v16, v16, v16 row_ror:4 row_mask:0xf bank_mask:0xf
    v_add_f32_dpp v17, v17, v17 row_ror:4 row_mask:0xf bank_mask:0xf
    v_add_f32_dpp v18, v18, v18 row_ror:4 row_mask:0xf bank_mask:0xf
    v_add_f32_dpp v19, v19, v19 row_ror:4 row_mask:0xf bank_mask:0xf
    v_add_f32_dpp v16, v16, v16 row_ror:2 row_mask:0xf bank_mask:0xf
    v_add_f32_dpp v17, v17, v17 row_ror:2 row_mask:0xf bank_mask:0xf
    v_add_f32_dpp v18, v18, v18 row_ror:2 row_mask:0xf bank_mask:0xf
    v_add_f32_dpp v19, v19, v19 row_ror:2 row_mask:0xf bank_mask:0xf
    v_add_f32_dpp v16, v16, v16 row_ror:1 row_mask:0xf bank_mask:0xf
    v_add_f32_dpp v17, v17, v17 row_ror:1 row_mask:0xf bank_mask:0xf
    v_add_f32_dpp v18, v18, v18 row_ror:1 row_mask:0xf bank_mask:0xf
    v_add_f32_dpp v19, v19, v19 row_ror:1 row_mask:0xf bank_mask:0xf
    v_mul_f32 v16, 0x3acccccd, v16
    v_mul_f32 v17, 0x3acccccd, v17
    v_fma_f32 v20, -v16, v16, v17
    v_max_f32 v20, 0, v20
    v_add_f32 v20, 0x3727c5ac, v20
    v_rsq_f32 v17, v20
    v_fma_f32 v18, -v16, v19, v18
    v_mul_f32 v18, v18, v17
    v_mul_f32 v18, 0xbfb8aa3b, v18
    v_exp_f32 v18, v18
    v_lshlrev_b32 v54, 16, v4
    v_add_f32 v18, 1.0, v18
    v_rcp_f32 v6, v18
    v_and_b32 v55, 0xffff0000, v4
    v_sub_f32 v18, v54, v16
    v_sub_f32 v19, v55, v16
    v_fma_f32 v54, v18, v17, v54
    v_fma_f32 v55, v19, v17, v55
    v_add_u32 v28, 1408, v61
    v_min_u32 v28, 1920, v28
    v_mov_b64 v[8:9], 0
    v_mov_b64 v[10:11], 0
    v_mov_b32 v29, 1920
    ds_write_b128 v29, v[8:11]
    s_add_u32 s65, s59, 81920
    s_cmp_eq_u32 s8, 0
    s_cbranch_scc0 L_last
    s_lshl_b32 s63, s5, 8
    s_add_u32 s63, s63, s58
    s_add_u32 s63, s63, 20480
    s_lshl_b32 s64, s5, 6
    s_add_u32 s64, s64, s58
    s_add_u32 s64, s64, 25600
    s_barrier
    ds_read_b128 v[24:27], v28
    s_waitcnt lgkmcnt(0)
    s_xor_b32 s66, s4, 0
    s_and_b32 s66, s66, 3
    s_lshl_b32 s66, s66, 9
    s_add_u32 s66, s66, s65
    s_xor_b32 s67, s4, 1
    s_and_b32 s67, s67, 3
    s_lshl_b32 s67, s67, 9
    s_add_u32 s67, s67, s65
    s_xor_b32 s68, s4, 2
    s_and_b32 s68, s68, 3
    s_lshl_b32 s68, s68, 9
    s_add_u32 s68, s68, s65
    s_xor_b32 s69, s4, 3
    s_and_b32 s69, s69, 3
    s_lshl_b32 s69, s69, 9
    s_add_u32 s69, s69, s65
    s_sleep 8
    s_or_b32 s10, s10, 31
L_nan51:
    s_sub_u32 s10, s10, 1
    s_and_b32 s71, s10, 31
    s_cbranch_scc0 L_exact54
L_retry52:
    buffer_load_dwordx4 v[32:35], v60, s[12:15], s66 offen sc1
    buffer_load_dwordx4 v[36:39], v62, s[12:15], s67 offen sc1
    buffer_load_dwordx4 v[40:43], v62, s[12:15], s68 offen sc1
    buffer_load_dwordx4 v[44:47], v62, s[12:15], s69 offen sc1
    s_cmp_eq_u32 s9, 0
    s_waitcnt vmcnt(3)
    v_pk_add_f32 v[8:9], v[32:33], v[24:25]
    v_pk_add_f32 v[10:11], v[34:35], v[26:27]
    s_waitcnt vmcnt(2)
    v_pk_add_f32 v[8:9], v[8:9], v[36:37]
    v_pk_add_f32 v[10:11], v[10:11], v[38:39]
    s_waitcnt vmcnt(1)
    v_pk_add_f32 v[8:9], v[8:9], v[40:41]
    v_pk_add_f32 v[10:11], v[10:11], v[42:43]
    s_waitcnt vmcnt(0)
    v_pk_add_f32 v[8:9], v[8:9], v[44:45]
    v_pk_add_f32 v[10:11], v[10:11], v[46:47]
    s_nop 0
    v_add_f32_dpp v48, v8, v8 row_ror:8 row_mask:0xf bank_mask:0x3
    v_add_f32_dpp v49, v9, v9 row_ror:8 row_mask:0xf bank_mask:0x3
    s_nop 0
    v_add_f32_dpp v48, v10, v10 row_ror:8 row_mask:0xf bank_mask:0xc
    v_add_f32_dpp v49, v11, v11 row_ror:8 row_mask:0xf bank_mask:0xc
    v_cmp_u_f32 vcc, v48, v49
    s_cbranch_vccnz L_nan51
L_ok53:
    v_fma_f32 v48, v48, v6, v54
    v_fma_f32 v49, v49, v6, v55
    v_cvt_pk_bf16_f32 v4, v48, v49
    s_cbranch_scc1 L_slow55
    buffer_store_dword v4, v63, s[12:15], s63 offen
L_back56:
    v_lshlrev_b32 v8, 16, v4
    v_and_b32 v9, 0xffff0000, v4
    v_add_f32 v51, v52, v53
    v_add_f32 v48, v8, v9
    v_mul_f32 v49, v8, v8
    v_mul_f32 v50, v8, v52
    v_fmac_f32 v49, v9, v9
    v_fmac_f32 v50, v9, v53
    v_add_f32_dpp v48, v48, v48 row_ror:8 row_mask:0xf bank_mask:0x3
    v_add_f32_dpp v49, v49, v49 row_ror:8 row_mask:0xf bank_mask:0x3
    s_nop 0
    v_add_f32_dpp v48, v50, v50 row_ror:8 row_mask:0xf bank_mask:0xc
    v_add_f32_dpp v49, v51, v51 row_ror:8 row_mask:0xf bank_mask:0xc
    s_nop 0
    v_add_f32_dpp v48, v48, v48 row_shl:4 row_mask:0xf bank_mask:0x5
    s_nop 1
    v_add_f32_dpp v48, v49, v49 row_shr:4 row_mask:0xf bank_mask:0xa
    s_nop 1
    v_add_f32_dpp v48, v48, v48 quad_perm:[1,0,3,2] row_mask:0xf bank_mask:0xf
    s_cmp_eq_u32 s9, 0
    s_nop 0
    v_add_f32_dpp v48, v48, v48 quad_perm:[2,3,0,1] row_mask:0xf bank_mask:0xf
    s_cbranch_scc1 L_slow57
    buffer_store_dword v48, v56, s[12:15], s64 offen
L_back58:
    s_branch L_q2
L_last:
    s_and_b32 s62, s5, 7
    s_cmp_eq_u32 s62, s4
    s_cbranch_scc0 L_fin
    s_mov_b32 s28, s52
    s_mov_b32 s29, s53
    s_mov_b32 s30, 5120
    s_mov_b32 s31, 0x20000
    s_lshl_b32 s62, s5, 6
    s_barrier
    ds_read_b128 v[24:27], v28
    s_waitcnt lgkmcnt(0)
    s_xor_b32 s66, s4, 0
    s_and_b32 s66, s66, 3
    s_lshl_b32 s66, s66, 9
    s_add_u32 s66, s66, s65
    s_xor_b32 s67, s4, 1
    s_and_b32 s67, s67, 3
    s_lshl_b32 s67, s67, 9
    s_add_u32 s67, s67, s65
    s_xor_b32 s68, s4, 2
    s_and_b32 s68, s68, 3
    s_lshl_b32 s68, s68, 9
    s_add_u32 s68, s68, s65
    s_xor_b32 s69, s4, 3
    s_and_b32 s69, s69, 3
    s_lshl_b32 s69, s69, 9
    s_add_u32 s69, s69, s65
    s_sleep 8
    s_or_b32 s10, s10, 31
L_nan59:
    s_sub_u32 s10, s10, 1
    s_and_b32 s71, s10, 31
    s_cbranch_scc0 L_exact62
L_retry60:
    buffer_load_dwordx4 v[32:35], v60, s[12:15], s66 offen sc1
    buffer_load_dwordx4 v[36:39], v62, s[12:15], s67 offen sc1
    buffer_load_dwordx4 v[40:43], v62, s[12:15], s68 offen sc1
    buffer_load_dwordx4 v[44:47], v62, s[12:15], s69 offen sc1
    s_cmp_eq_u32 s9, 0
    s_waitcnt vmcnt(3)
    v_pk_add_f32 v[8:9], v[32:33], v[24:25]
    v_pk_add_f32 v[10:11], v[34:35], v[26:27]
    s_waitcnt vmcnt(2)
    v_pk_add_f32 v[8:9], v[8:9], v[36:37]
    v_pk_add_f32 v[10:11], v[10:11], v[38:39]
    s_waitcnt vmcnt(1)
    v_pk_add_f32 v[8:9], v[8:9], v[40:41]
    v_pk_add_f32 v[10:11], v[10:11], v[42:43]
    s_waitcnt vmcnt(0)
    v_pk_add_f32 v[8:9], v[8:9], v[44:45]
    v_pk_add_f32 v[10:11], v[10:11], v[46:47]
    s_nop 0
    v_add_f32_dpp v48, v8, v8 row_ror:8 row_mask:0xf bank_mask:0x3
    v_add_f32_dpp v49, v9, v9 row_ror:8 row_mask:0xf bank_mask:0x3
    s_nop 0
    v_add_f32_dpp v48, v10, v10 row_ror:8 row_mask:0xf bank_mask:0xc
    v_add_f32_dpp v49, v11, v11 row_ror:8 row_mask:0xf bank_mask:0xc
    v_cmp_u_f32 vcc, v48, v49
    s_cbranch_vccnz L_nan59
L_ok61:
    v_fma_f32 v48, v48, v6, v54
    v_fma_f32 v49, v49, v6, v55
    v_cvt_pk_bf16_f32 v48, v48, v49
    buffer_store_dword v48, v57, s[28:31], s62 offen
    s_branch L_fin
L_own_rest:
    s_waitcnt lgkmcnt(0)
    s_barrier
    s_cmp_eq_u32 s61, 1
    s_cbranch_scc1 L_down
    s_cmp_eq_u32 s8, 0
    s_cbranch_scc0 L_fin
    s_cmp_eq_u32 s3, 7
    s_cbranch_scc0 L_nocs63
    v_lshlrev_b32 v28, 3, v0
    v_mov_b32 v29, 592
    ds_read_b64 v[8:9], v28 offset:640
    ds_read_b64 v[12:13], v28 offset:1152
    ds_read_b64 v[10:11], v29
    ds_read_b64 v[14:15], v29
    s_mul_i32 s69, s4, 49152
    s_mul_i32 s71, s6, 12288
    s_add_u32 s69, s69, s71
    s_mul_i32 s71, s7, 1536
    s_add_u32 s69, s69, s71
    s_add_u32 s69, s69, 2293760
    s_waitcnt lgkmcnt(0)
    s_cmp_eq_u32 s9, 0
    s_cbranch_scc1 L_slow64
    buffer_store_dwordx4 v[8:11], v3, s[12:15], s69 offen
L_back65:
    s_mov_b32 exec_hi, 0
    s_cmp_eq_u32 s9, 0
    s_cbranch_scc1 L_slow66
    buffer_store_dwordx4 v[12:15], v3, s[12:15], s69 offen offset:1024
L_back67:
    s_mov_b32 exec_hi, -1
L_nocs63:
    s_barrier
    s_sub_u32 s70, s3, 1
    s_cmp_lt_u32 s70, 6
    s_cbranch_scc0 L_noq68
    ds_read_b128 v[56:59], v3 offset:17792
    s_lshl_b32 s70, s70, 6
    s_waitcnt lgkmcnt(0)
    v_add_u32 v58, s70, v58
    v_add_u32 v59, s70, v59
    ds_read_b64_tr_b16 v[32:33], v58 offset:0
    ds_read_b64_tr_b16 v[34:35], v58 offset:1536
    ds_read_b64_tr_b16 v[36:37], v58 offset:12288
    ds_read_b64_tr_b16 v[38:39], v58 offset:13824
    ds_read_b64_tr_b16 v[40:41], v59 offset:24576
    ds_read_b64_tr_b16 v[42:43], v59 offset:26112
    ds_read_b64_tr_b16 v[44:45], v58 offset:32
    ds_read_b64_tr_b16 v[46:47], v58 offset:1568
    ds_read_b64_tr_b16 v[48:49], v58 offset:12320
    ds_read_b64_tr_b16 v[50:51], v58 offset:13856
    ds_read_b64_tr_b16 v[52:53], v59 offset:24608
    ds_read_b64_tr_b16 v[54:55], v59 offset:26144
L_noq68:
    s_cmp_eq_u32 s3, 7
    s_cbranch_scc0 L_no769
    v_mov_b32 v7, 592
    ds_read_b64 v[62:63], v7
    ds_read_b128 v[56:59], v3 offset:15744
    v_lshlrev_b32 v60, 5, v0
    s_mul_i32 s70, s4, 49152
    s_mul_i32 s71, s6, 12288
    s_add_u32 s70, s70, s71
    s_add_u32 s70, s70, 2293760
    v_mov_b32 v44, 0
    v_mov_b32 v45, 0
    v_mov_b32 v46, 0
    v_mov_b32 v47, 0
    s_mov_b32 exec_lo, 0xffffffff
    s_mov_b32 exec_hi, 0xffff
L_retry70:
    s_sub_u32 s10, s10, 1
    s_cbranch_scc1 L_give72
    buffer_load_dwordx4 v[8:11], v60, s[12:15], s70 offen offset:0 sc1
    buffer_load_dwordx4 v[12:15], v60, s[12:15], s70 offen offset:16 sc1
    buffer_load_dwordx4 v[16:19], v60, s[12:15], s70 offen offset:1536 sc1
    buffer_load_dwordx4 v[20:23], v60, s[12:15], s70 offen offset:1552 sc1
    s_add_u32 s69, s70, 3072
    buffer_load_dwordx4 v[24:27], v60, s[12:15], s69 offen sc1
    buffer_load_dwordx4 v[28:31], v60, s[12:15], s69 offen offset:16 sc1
    buffer_load_dwordx4 v[32:35], v60, s[12:15], s69 offen offset:1536 sc1
    buffer_load_dwordx4 v[36:39], v60, s[12:15], s69 offen offset:1552 sc1
    v_mov_b32 v7, 0
    s_waitcnt vmcnt(0) lgkmcnt(0)
    v_xor_b32 v10, v62, v10
    v_xor_b32 v11, v63, v11
    v_or3_b32 v7, v7, v10, v11
    v_xor_b32 v14, v62, v14
    v_xor_b32 v15, v63, v15
    v_or3_b32 v7, v7, v14, v15
    v_xor_b32 v18, v62, v18
    v_xor_b32 v19, v63, v19
    v_or3_b32 v7, v7, v18, v19
    v_xor_b32 v22, v62, v22
    v_xor_b32 v23, v63, v23
    v_or3_b32 v7, v7, v22, v23
    v_xor_b32 v26, v62, v26
    v_xor_b32 v27, v63, v27
    v_or3_b32 v7, v7, v26, v27
    v_xor_b32 v30, v62, v30
    v_xor_b32 v31, v63, v31
    v_or3_b32 v7, v7, v30, v31
    v_xor_b32 v34, v62, v34
    v_xor_b32 v35, v63, v35
    v_or3_b32 v7, v7, v34, v35
    v_xor_b32 v38, v62, v38
    v_xor_b32 v39, v63, v39
    v_or3_b32 v7, v7, v38, v39
    v_cmp_ne_u32 vcc, 0, v7
    s_cbranch_vccnz L_retry70
L_ok71:
    v_pk_add_f32 v[44:45], v[44:45], v[8:9]
    v_pk_add_f32 v[46:47], v[46:47], v[12:13]
    v_pk_add_f32 v[44:45], v[44:45], v[16:17]
    v_pk_add_f32 v[46:47], v[46:47], v[20:21]
    v_pk_add_f32 v[44:45], v[44:45], v[24:25]
    v_pk_add_f32 v[46:47], v[46:47], v[28:29]
    v_pk_add_f32 v[44:45], v[44:45], v[32:33]
    v_pk_add_f32 v[46:47], v[46:47], v[36:37]
    s_add_u32 s70, s70, 6144
L_retry73:
    s_sub_u32 s10, s10, 1
    s_cbranch_scc1 L_give75
    buffer_load_dwordx4 v[8:11], v60, s[12:15], s70 offen offset:0 sc1
    buffer_load_dwordx4 v[12:15], v60, s[12:15], s70 offen offset:16 sc1
    buffer_load_dwordx4 v[16:19], v60, s[12:15], s70 offen offset:1536 sc1
    buffer_load_dwordx4 v[20:23], v60, s[12:15], s70 offen offset:1552 sc1
    s_add_u32 s69, s70, 3072
    buffer_load_dwordx4 v[24:27], v60, s[12:15], s69 offen sc1
    buffer_load_dwordx4 v[28:31], v60, s[12:15], s69 offen offset:16 sc1
    buffer_load_dwordx4 v[32:35], v60, s[12:15], s69 offen offset:1536 sc1
    buffer_load_dwordx4 v[36:39], v60, s[12:15], s69 offen offset:1552 sc1
    v_mov_b32 v7, 0
    s_waitcnt vmcnt(0) lgkmcnt(0)
    v_xor_b32 v10, v62, v10
    v_xor_b32 v11, v63, v11
    v_or3_b32 v7, v7, v10, v11
    v_xor_b32 v14, v62, v14
    v_xor_b32 v15, v63, v15
    v_or3_b32 v7, v7, v14, v15
    v_xor_b32 v18, v62, v18
    v_xor_b32 v19, v63, v19
    v_or3_b32 v7, v7, v18, v19
    v_xor_b32 v22, v62, v22
    v_xor_b32 v23, v63, v23
    v_or3_b32 v7, v7, v22, v23
    v_xor_b32 v26, v62, v26
    v_xor_b32 v27, v63, v27
    v_or3_b32 v7, v7, v26, v27
    v_xor_b32 v30, v62, v30
    v_xor_b32 v31, v63, v31
    v_or3_b32 v7, v7, v30, v31
    v_xor_b32 v34, v62, v34
    v_xor_b32 v35, v63, v35
    v_or3_b32 v7, v7, v34, v35
    v_xor_b32 v38, v62, v38
    v_xor_b32 v39, v63, v39
    v_or3_b32 v7, v7, v38, v39
    v_cmp_ne_u32 vcc, 0, v7
    s_cbranch_vccnz L_retry73
L_ok74:
    v_pk_add_f32 v[44:45], v[44:45], v[8:9]
    v_pk_add_f32 v[46:47], v[46:47], v[12:13]
    v_pk_add_f32 v[44:45], v[44:45], v[16:17]
    v_pk_add_f32 v[46:47], v[46:47], v[20:21]
    v_pk_add_f32 v[44:45], v[44:45], v[24:25]
    v_pk_add_f32 v[46:47], v[46:47], v[28:29]
    v_pk_add_f32 v[44:45], v[44:45], v[32:33]
    v_pk_add_f32 v[46:47], v[46:47], v[36:37]
    s_add_u32 s70, s70, 6144
    s_mov_b64 exec, -1
L_no769:
    s_barrier
    s_branch L_q2
L_down:
    s_setprio 2
    s_mul_i32 s68, s60, 6144
    s_add_u32 s68, s68, 113024
    v_add_u32 v7, s68, v2
    ds_read_b128 v[60:63], v3 offset:16768
    s_cmp_eq_u32 s8, 0
    s_cbranch_scc0 L_down1
    s_mov_b32 s16, s50
    s_mov_b32 s17, s51
    s_mov_b32 s18, 1966080
    s_mov_b32 s19, 0x20000
    v_lshrrev_b32 v28, 1, v0
    v_mul_u32_u24 v28, 1280, v28
    v_and_b32 v29, 1, v0
    v_lshl_add_u32 v28, v29, 4, v28
    s_mul_i32 s67, s4, 245760
    s_lshl_b32 s71, s5, 6
    s_add_u32 s67, s67, s71
    s_lshl_b32 s71, s60, 5
    s_add_u32 s67, s67, s71
    s_and_b32 s69, s5, 1
    s_mul_i32 s69, s69, 3
    s_add_u32 s69, s69, s60
    s_barrier
    s_add_u32 s70, s69, 0
    s_sub_u32 s71, s70, 6
    s_cselect_b32 s70, s70, s71
    s_mul_i32 s71, s70, 40960
    s_lshl_b32 s70, s70, 10
    s_add_u32 m0, s70, s68
    s_add_u32 s71, s71, s67
    buffer_load_dwordx4 v28, s[16:19], s71 offen lds
    s_add_u32 s70, s69, 1
    s_sub_u32 s71, s70, 6
    s_cselect_b32 s70, s70, s71
    s_mul_i32 s71, s70, 40960
    s_lshl_b32 s70, s70, 10
    s_add_u32 m0, s70, s68
    s_add_u32 s71, s71, s67
    buffer_load_dwordx4 v28, s[16:19], s71 offen lds
    s_add_u32 s70, s69, 2
    s_sub_u32 s71, s70, 6
    s_cselect_b32 s70, s70, s71
    s_mul_i32 s71, s70, 40960
    s_lshl_b32 s70, s70, 10
    s_add_u32 m0, s70, s68
    s_add_u32 s71, s71, s67
    buffer_load_dwordx4 v28, s[16:19], s71 offen lds
    s_add_u32 s70, s69, 3
    s_sub_u32 s71, s70, 6
    s_cselect_b32 s70, s70, s71
    s_mul_i32 s71, s70, 40960
    s_lshl_b32 s70, s70, 10
    s_add_u32 m0, s70, s68
    s_add_u32 s71, s71, s67
    buffer_load_dwordx4 v28, s[16:19], s71 offen lds
    s_add_u32 s70, s69, 4
    s_sub_u32 s71, s70, 6
    s_cselect_b32 s70, s70, s71
    s_mul_i32 s71, s70, 40960
    s_lshl_b32 s70, s70, 10
    s_add_u32 m0, s70, s68
    s_add_u32 s71, s71, s67
    buffer_load_dwordx4 v28, s[16:19], s71 offen lds
    s_add_u32 s70, s69, 5
    s_sub_u32 s71, s70, 6
    s_cselect_b32 s70, s70, s71
    s_mul_i32 s71, s70, 40960
    s_lshl_b32 s70, s70, 10
    s_add_u32 m0, s70, s68
    s_add_u32 s71, s71, s67
    buffer_load_dwordx4 v28, s[16:19], s71 offen lds
    s_cmp_eq_u32 s60, 0
    s_cbranch_scc0 L_clr3
    s_waitcnt vmcnt(0)
    s_branch L_down1
L_clr3:
    s_mul_i32 s67, s4, 20480
    s_lshl_b32 s71, s5, 10
    s_add_u32 s67, s67, s71
    s_add_u32 s67, s67, 557056
    v_mov_b32 v24, -1
    v_mov_b32 v25, -1
    v_mov_b32 v26, -1
    v_mov_b32 v27, -1
    buffer_store_dwordx4 v[24:27], v3, s[12:15], s67 offen sc1
    s_waitcnt vmcnt(1)
L_down1:
    ds_read_b64_tr_b16 v[32:33], v7 offset:0
    ds_read_b64_tr_b16 v[34:35], v7 offset:128
    ds_read_b64_tr_b16 v[36:37], v7 offset:1024
    ds_read_b64_tr_b16 v[38:39], v7 offset:1152
    ds_read_b64_tr_b16 v[40:41], v7 offset:2048
    ds_read_b64_tr_b16 v[42:43], v7 offset:2176
    ds_read_b64_tr_b16 v[44:45], v7 offset:3072
    ds_read_b64_tr_b16 v[46:47], v7 offset:3200
    ds_read_b64_tr_b16 v[48:49], v7 offset:4096
    ds_read_b64_tr_b16 v[50:51], v7 offset:4224
    ds_read_b64_tr_b16 v[52:53], v7 offset:5120
    ds_read_b64_tr_b16 v[54:55], v7 offset:5248
    s_lshl_b32 s62, s60, 8
    s_add_u32 s62, s62, 1408
    s_waitcnt lgkmcnt(12)
    v_add_u32 v61, s62, v63
    v_add_u32 v62, 125312, v3
    v_min_u32 v61, v61, v62
    s_add_u32 s62, s58, 18944
    s_lshl_b32 s63, s4, 9
    s_lshl_b32 s71, s60, 8
    s_add_u32 s63, s63, s71
    s_add_u32 s63, s63, s59
    s_add_u32 s63, s63, 81920
L_retry76:
    s_sub_u32 s10, s10, 1
    s_cbranch_scc1 L_give78
    buffer_load_dwordx4 v[8:11], v1, s[12:15], s62 offen offset:0 sc1
    buffer_load_dwordx4 v[12:15], v1, s[12:15], s62 offen offset:256 sc1
    buffer_load_dwordx4 v[16:19], v1, s[12:15], s62 offen offset:512 sc1
    buffer_load_dwordx4 v[20:23], v1, s[12:15], s62 offen offset:768 sc1
    buffer_load_dwordx4 v[24:27], v1, s[12:15], s62 offen offset:1024 sc1
    buffer_load_dwordx4 v[28:31], v1, s[12:15], s62 offen offset:1280 sc1
    s_waitcnt vmcnt(0) lgkmcnt(0)
    v_max3_u32 v7, v11, v15, v19
    v_max3_u32 v7, v7, v23, v27
    v_max_u32 v7, v7, v31
    v_cmp_eq_u32 vcc, -1, v7
    s_cbranch_vccnz L_retry76
    v_mfma_f32_16x16x32_bf16 v[56:59], v[32:35], v[8:11], 0
    v_max3_u32 v7, v8, v9, v10
    v_max3_u32 v7, v7, v11, v12
    v_mfma_f32_16x16x32_bf16 v[56:59], v[36:39], v[12:15], v[56:59]
    v_max3_u32 v7, v7, v13, v14
    v_max3_u32 v7, v7, v15, v16
    v_mfma_f32_16x16x32_bf16 v[56:59], v[40:43], v[16:19], v[56:59]
    v_max3_u32 v7, v7, v17, v18
    v_max3_u32 v7, v7, v19, v20
    v_mfma_f32_16x16x32_bf16 v[56:59], v[44:47], v[20:23], v[56:59]
    v_max3_u32 v7, v7, v21, v22
    v_max3_u32 v7, v7, v23, v24
    v_mfma_f32_16x16x32_bf16 v[56:59], v[48:51], v[24:27], v[56:59]
    v_max3_u32 v7, v7, v25, v26
    v_max3_u32 v7, v7, v27, v28
    v_mfma_f32_16x16x32_bf16 v[56:59], v[52:55], v[28:31], v[56:59]
    v_max3_u32 v7, v7, v29, v30
    v_max_u32 v7, v7, v31
    v_cmp_eq_u32 vcc, -1, v7
    s_cbranch_vccnz L_retry76
L_ok77:
    s_nop 3
    buffer_store_dwordx4 v[56:59], v63, s[12:15], s63 offen sc1
    ds_write_b128 v61, v[56:59]
    s_waitcnt lgkmcnt(0)
    s_barrier
    s_cmp_eq_u32 s8, 0
    s_cbranch_scc0 L_fin
    s_sub_u32 s70, s3, 1
    s_cmp_lt_u32 s70, 6
    s_cbranch_scc0 L_noq79
    ds_read_b128 v[56:59], v3 offset:17792
    s_lshl_b32 s70, s70, 6
    s_waitcnt lgkmcnt(0)
    v_add_u32 v58, s70, v58
    v_add_u32 v59, s70, v59
    ds_read_b64_tr_b16 v[32:33], v58 offset:0
    ds_read_b64_tr_b16 v[34:35], v58 offset:1536
    ds_read_b64_tr_b16 v[36:37], v58 offset:12288
    ds_read_b64_tr_b16 v[38:39], v58 offset:13824
    ds_read_b64_tr_b16 v[40:41], v59 offset:24576
    ds_read_b64_tr_b16 v[42:43], v59 offset:26112
    ds_read_b64_tr_b16 v[44:45], v58 offset:32
    ds_read_b64_tr_b16 v[46:47], v58 offset:1568
    ds_read_b64_tr_b16 v[48:49], v58 offset:12320
    ds_read_b64_tr_b16 v[50:51], v58 offset:13856
    ds_read_b64_tr_b16 v[52:53], v59 offset:24608
    ds_read_b64_tr_b16 v[54:55], v59 offset:26144
L_noq79:
    s_cmp_eq_u32 s3, 7
    s_cbranch_scc0 L_no780
    v_mov_b32 v7, 592
    ds_read_b64 v[62:63], v7
    ds_read_b128 v[56:59], v3 offset:15744
    v_lshlrev_b32 v60, 5, v0
    s_mul_i32 s70, s4, 49152
    s_mul_i32 s71, s6, 12288
    s_add_u32 s70, s70, s71
    s_add_u32 s70, s70, 2293760
    v_mov_b32 v44, 0
    v_mov_b32 v45, 0
    v_mov_b32 v46, 0
    v_mov_b32 v47, 0
    s_mov_b32 exec_lo, 0xffffffff
    s_mov_b32 exec_hi, 0xffff
L_retry81:
    s_sub_u32 s10, s10, 1
    s_cbranch_scc1 L_give83
    buffer_load_dwordx4 v[8:11], v60, s[12:15], s70 offen offset:0 sc1
    buffer_load_dwordx4 v[12:15], v60, s[12:15], s70 offen offset:16 sc1
    buffer_load_dwordx4 v[16:19], v60, s[12:15], s70 offen offset:1536 sc1
    buffer_load_dwordx4 v[20:23], v60, s[12:15], s70 offen offset:1552 sc1
    s_add_u32 s69, s70, 3072
    buffer_load_dwordx4 v[24:27], v60, s[12:15], s69 offen sc1
    buffer_load_dwordx4 v[28:31], v60, s[12:15], s69 offen offset:16 sc1
    buffer_load_dwordx4 v[32:35], v60, s[12:15], s69 offen offset:1536 sc1
    buffer_load_dwordx4 v[36:39], v60, s[12:15], s69 offen offset:1552 sc1
    v_mov_b32 v7, 0
    s_waitcnt vmcnt(0) lgkmcnt(0)
    v_xor_b32 v10, v62, v10
    v_xor_b32 v11, v63, v11
    v_or3_b32 v7, v7, v10, v11
    v_xor_b32 v14, v62, v14
    v_xor_b32 v15, v63, v15
    v_or3_b32 v7, v7, v14, v15
    v_xor_b32 v18, v62, v18
    v_xor_b32 v19, v63, v19
    v_or3_b32 v7, v7, v18, v19
    v_xor_b32 v22, v62, v22
    v_xor_b32 v23, v63, v23
    v_or3_b32 v7, v7, v22, v23
    v_xor_b32 v26, v62, v26
    v_xor_b32 v27, v63, v27
    v_or3_b32 v7, v7, v26, v27
    v_xor_b32 v30, v62, v30
    v_xor_b32 v31, v63, v31
    v_or3_b32 v7, v7, v30, v31
    v_xor_b32 v34, v62, v34
    v_xor_b32 v35, v63, v35
    v_or3_b32 v7, v7, v34, v35
    v_xor_b32 v38, v62, v38
    v_xor_b32 v39, v63, v39
    v_or3_b32 v7, v7, v38, v39
    v_cmp_ne_u32 vcc, 0, v7
    s_cbranch_vccnz L_retry81
L_ok82:
    v_pk_add_f32 v[44:45], v[44:45], v[8:9]
    v_pk_add_f32 v[46:47], v[46:47], v[12:13]
    v_pk_add_f32 v[44:45], v[44:45], v[16:17]
    v_pk_add_f32 v[46:47], v[46:47], v[20:21]
    v_pk_add_f32 v[44:45], v[44:45], v[24:25]
    v_pk_add_f32 v[46:47], v[46:47], v[28:29]
    v_pk_add_f32 v[44:45], v[44:45], v[32:33]
    v_pk_add_f32 v[46:47], v[46:47], v[36:37]
    s_add_u32 s70, s70, 6144
L_retry84:
    s_sub_u32 s10, s10, 1
    s_cbranch_scc1 L_give86
    buffer_load_dwordx4 v[8:11], v60, s[12:15], s70 offen offset:0 sc1
    buffer_load_dwordx4 v[12:15], v60, s[12:15], s70 offen offset:16 sc1
    buffer_load_dwordx4 v[16:19], v60, s[12:15], s70 offen offset:1536 sc1
    buffer_load_dwordx4 v[20:23], v60, s[12:15], s70 offen offset:1552 sc1
    s_add_u32 s69, s70, 3072
    buffer_load_dwordx4 v[24:27], v60, s[12:15], s69 offen sc1
    buffer_load_dwordx4 v[28:31], v60, s[12:15], s69 offen offset:16 sc1
    buffer_load_dwordx4 v[32:35], v60, s[12:15], s69 offen offset:1536 sc1
    buffer_load_dwordx4 v[36:39], v60, s[12:15], s69 offen offset:1552 sc1
    v_mov_b32 v7, 0
    s_waitcnt vmcnt(0) lgkmcnt(0)
    v_xor_b32 v10, v62, v10
    v_xor_b32 v11, v63, v11
    v_or3_b32 v7, v7, v10, v11
    v_xor_b32 v14, v62, v14
    v_xor_b32 v15, v63, v15
    v_or3_b32 v7, v7, v14, v15
    v_xor_b32 v18, v62, v18
    v_xor_b32 v19, v63, v19
    v_or3_b32 v7, v7, v18, v19
    v_xor_b32 v22, v62, v22
    v_xor_b32 v23, v63, v23
    v_or3_b32 v7, v7, v22, v23
    v_xor_b32 v26, v62, v26
    v_xor_b32 v27, v63, v27
    v_or3_b32 v7, v7, v26, v27
    v_xor_b32 v30, v62, v30
    v_xor_b32 v31, v63, v31
    v_or3_b32 v7, v7, v30, v31
    v_xor_b32 v34, v62, v34
    v_xor_b32 v35, v63, v35
    v_or3_b32 v7, v7, v34, v35
    v_xor_b32 v38, v62, v38
    v_xor_b32 v39, v63, v39
    v_or3_b32 v7, v7, v38, v39
    v_cmp_ne_u32 vcc, 0, v7
    s_cbranch_vccnz L_retry84
L_ok85:
    v_pk_add_f32 v[44:45], v[44:45], v[8:9]
    v_pk_add_f32 v[46:47], v[46:47], v[12:13]
    v_pk_add_f32 v[44:45], v[44:45], v[16:17]
    v_pk_add_f32 v[46:47], v[46:47], v[20:21]
    v_pk_add_f32 v[44:45], v[44:45], v[24:25]
    v_pk_add_f32 v[46:47], v[46:47], v[28:29]
    v_pk_add_f32 v[44:45], v[44:45], v[32:33]
    v_pk_add_f32 v[46:47], v[46:47], v[36:37]
    s_add_u32 s70, s70, 6144
    s_mov_b64 exec, -1
L_no780:
    s_branch L_q2
L_gu:
    s_mul_i32 s68, s3, 5120
    s_add_u32 s68, s68, 63872
    v_add_u32 v63, s68, v2
    s_waitcnt lgkmcnt(0)
    s_barrier
    ds_read_b128 v[20:23], v17 offset:0
    ds_read_b128 v[8:11], v16
    ds_read_b128 v[12:15], v16 offset:768
    ds_read_b128 v[56:59], v3 offset:16768
    s_waitcnt lgkmcnt(3)
    v_max_f32_dpp v24, v20, v20 row_ror:8 row_mask:0xf bank_mask:0xf
    v_readfirstlane_b32 s9, v22
    s_nop 0
    v_max_f32_dpp v24, v24, v24 row_bcast:15 row_mask:0xa bank_mask:0xf
    s_waitcnt lgkmcnt(1)
    v_pk_add_f32 v[8:9], v[8:9], v[12:13]
    v_max_f32_dpp v24, v24, v24 row_bcast:31 row_mask:0xc bank_mask:0xf
    v_pk_add_f32 v[10:11], v[10:11], v[14:15]
    v_readlane_b32 s66, v24, 63
    s_cmp_eq_u32 s9, 0
    s_nop 0
    v_subrev_f32 v20, s66, v20
    v_exp_f32 v20, v20
    s_nop 0
    v_mul_f32 v21, v21, v20
    v_pk_mul_f32 v[8:9], v[8:9], v[20:21] op_sel_hi:[1,0]
    v_pk_mul_f32 v[10:11], v[10:11], v[20:21] op_sel_hi:[1,0]
    v_add_f32_dpp v21, v21, v21 row_ror:8 row_mask:0xf bank_mask:0xf
    v_mov_b32 v20, s66
    v_permlane32_swap_b32 v8, v10
    v_permlane32_swap_b32 v9, v11
    v_pk_add_f32 v[8:9], v[8:9], v[10:11]
    v_add_f32_dpp v21, v21, v21 row_bcast:15 row_mask:0xa bank_mask:0xf
    s_waitcnt lgkmcnt(0)
    v_permlane16_swap_b32 v8, v9
    v_add_f32 v8, v8, v9
    v_add_f32_dpp v21, v21, v21 row_bcast:31 row_mask:0xc bank_mask:0xf
    s_nop 0
    v_add_f32_dpp v8, v8, v8 row_ror:8 row_mask:0xf bank_mask:0xf
    v_mov_b32 v9, v8
    s_nop 1
    v_permlane16_swap_b32 v9, v8
    v_cvt_pk_bf16_f32 v8, v9, v8
    s_cbranch_scc1 L_slow87
    buffer_store_dword v8, v18, s[12:15], s20 offen
    buffer_store_dwordx2 v[20:21], v19, s[12:15], s21 offen
L_back88:
    s_cmp_eq_u32 s8, 0
    s_cbranch_scc0 L_gu1
    s_barrier
    s_add_u32 s70, s30, 1
    s_sub_u32 s71, s70, 5
    s_cselect_b32 s70, s70, s71
    s_mul_i32 s71, s70, 98304
    s_lshl_b32 s70, s70, 10
    s_add_u32 m0, s70, s29
    s_add_u32 s71, s71, s28
    buffer_load_dwordx4 v59, s[16:19], s71 offen lds
    s_add_u32 s70, s30, 2
    s_sub_u32 s71, s70, 5
    s_cselect_b32 s70, s70, s71
    s_mul_i32 s71, s70, 98304
    s_lshl_b32 s70, s70, 10
    s_add_u32 m0, s70, s29
    s_add_u32 s71, s71, s28
    buffer_load_dwordx4 v59, s[16:19], s71 offen lds
    s_add_u32 s70, s30, 3
    s_sub_u32 s71, s70, 5
    s_cselect_b32 s70, s70, s71
    s_mul_i32 s71, s70, 98304
    s_lshl_b32 s70, s70, 10
    s_add_u32 m0, s70, s29
    s_add_u32 s71, s71, s28
    buffer_load_dwordx4 v59, s[16:19], s71 offen lds
    s_add_u32 s70, s30, 4
    s_sub_u32 s71, s70, 5
    s_cselect_b32 s70, s70, s71
    s_mul_i32 s71, s70, 98304
    s_lshl_b32 s70, s70, 10
    s_add_u32 m0, s70, s29
    s_add_u32 s71, s71, s28
    buffer_load_dwordx4 v59, s[16:19], s71 offen lds
    v_mov_b32 v24, -1
    v_mov_b32 v25, -1
    v_mov_b32 v26, -1
    v_mov_b32 v27, -1
    s_cmp_eq_u32 s9, 0
    s_cbranch_scc1 L_slow89
    buffer_store_dwordx4 v[24:27], v3, s[12:15], s31 offen
L_back90:
    buffer_load_dwordx4 v[16:19], v3, s[12:15], s31 offen sc1
    s_mov_b32 s16, s50
    s_mov_b32 s17, s51
    s_mov_b32 s18, 1966080
    s_mov_b32 s19, 0x20000
    s_mul_i32 s67, s4, 245760
    s_mul_i32 s71, s5, 20480
    s_add_u32 s67, s67, s71
    s_mul_i32 s71, s3, 2560
    s_add_u32 s67, s67, s71
    s_add_u32 s67, s67, 4294557696
    v_lshlrev_b32 v28, 7, v0
    s_mov_b32 exec_lo, 0xfffff
    s_mov_b32 exec_hi, 0x0
    buffer_load_dword v7, v28, s[16:19], s67 offen
    s_mov_b64 exec, -1
    s_waitcnt vmcnt(3)
    s_barrier
L_gu1:
    ds_read_b64_tr_b16 v[32:33], v63 offset:0
    ds_read_b64_tr_b16 v[34:35], v63 offset:128
    ds_read_b64_tr_b16 v[36:37], v63 offset:1024
    ds_read_b64_tr_b16 v[38:39], v63 offset:1152
    ds_read_b64_tr_b16 v[40:41], v63 offset:2048
    ds_read_b64_tr_b16 v[42:43], v63 offset:2176
    ds_read_b64_tr_b16 v[44:45], v63 offset:3072
    ds_read_b64_tr_b16 v[46:47], v63 offset:3200
    ds_read_b64_tr_b16 v[48:49], v63 offset:4096
    ds_read_b64_tr_b16 v[50:51], v63 offset:4224
    s_cmp_eq_u32 s3, 0
    s_cbranch_scc0 L_np1
    s_setprio 3
L_np1:
    s_lshl_b32 s64, s3, 8
    v_add_u32 v56, s64, v56
    s_cmp_eq_u32 s8, 0
    s_cbranch_scc0 L_gu2
    v_mov_b32 v8, 0x3f803f80
    v_mov_b32 v9, 0x3f803f80
    v_mov_b32 v10, 0x3f803f80
    v_mov_b32 v11, 0x3f803f80
    s_waitcnt lgkmcnt(0)
    s_nop 0
    v_mfma_f32_16x16x32_bf16 v[52:55], v[32:35], v[8:11], 0
    v_mfma_f32_16x16x32_bf16 v[52:55], v[36:39], v[8:11], v[52:55]
    v_mfma_f32_16x16x32_bf16 v[52:55], v[40:43], v[8:11], v[52:55]
    v_mfma_f32_16x16x32_bf16 v[52:55], v[44:47], v[8:11], v[52:55]
    v_mfma_f32_16x16x32_bf16 v[52:55], v[48:51], v[8:11], v[52:55]
    s_nop 7
    ds_write_b128 v56, v[52:55] offset:2048
    s_waitcnt lgkmcnt(0)
    s_barrier
    ds_read_b128 v[24:27], v57 offset:2048
    ds_read_b128 v[28:31], v57 offset:2304
    s_waitcnt lgkmcnt(0)
    v_add_f32_dpp v24, v24, v24 row_ror:8 row_mask:0xf bank_mask:0x3
    v_add_f32_dpp v28, v28, v28 row_ror:8 row_mask:0xf bank_mask:0x3
    v_add_f32_dpp v25, v25, v25 row_ror:8 row_mask:0xf bank_mask:0x3
    v_add_f32_dpp v29, v29, v29 row_ror:8 row_mask:0xf bank_mask:0x3
    v_add_f32_dpp v24, v26, v26 row_ror:8 row_mask:0xf bank_mask:0xc
    v_add_f32_dpp v28, v30, v30 row_ror:8 row_mask:0xf bank_mask:0xc
    v_add_f32_dpp v25, v27, v27 row_ror:8 row_mask:0xf bank_mask:0xc
    v_add_f32_dpp v29, v31, v31 row_ror:8 row_mask:0xf bank_mask:0xc
    v_add_f32_dpp v24, v24, v24 row_shl:4 row_mask:0xf bank_mask:0x5
    v_add_f32_dpp v28, v28, v28 row_shl:4 row_mask:0xf bank_mask:0x5
    s_nop 0
    v_add_f32_dpp v24, v25, v25 row_shr:4 row_mask:0xf bank_mask:0xa
    v_add_f32_dpp v28, v29, v29 row_shr:4 row_mask:0xf bank_mask:0xa
    v_mov_b32 v4, v24
    v_mov_b32 v5, v28
    s_cmp_eq_u32 s3, 7
    s_cbranch_scc0 L_nocs91
    v_lshlrev_b32 v28, 3, v0
    v_mov_b32 v29, 592
    ds_read_b64 v[8:9], v28 offset:640
    ds_read_b64 v[12:13], v28 offset:1152
    ds_read_b64 v[10:11], v29
    ds_read_b64 v[14:15], v29
    s_mul_i32 s69, s4, 49152
    s_mul_i32 s71, s6, 12288
    s_add_u32 s69, s69, s71
    s_mul_i32 s71, s7, 1536
    s_add_u32 s69, s69, s71
    s_add_u32 s69, s69, 2293760
    s_waitcnt lgkmcnt(0)
    s_cmp_eq_u32 s9, 0
    s_cbranch_scc1 L_slow92
    buffer_store_dwordx4 v[8:11], v3, s[12:15], s69 offen
L_back93:
    s_mov_b32 exec_hi, 0
    s_cmp_eq_u32 s9, 0
    s_cbranch_scc1 L_slow94
    buffer_store_dwordx4 v[12:15], v3, s[12:15], s69 offen offset:1024
L_back95:
    s_mov_b32 exec_hi, -1
L_nocs91:
L_gu2:
    ds_read_b128 v[60:63], v3 offset:15744
    s_mul_i32 s66, s61, 1280
    s_add_u32 s66, s66, s58
    s_add_u32 s66, s66, 12544
    s_add_u32 s67, s58, 17664
    s_lshl_b32 s65, s5, 7
    s_add_u32 s65, s65, s58
    s_add_u32 s65, s65, 16384
L_retry96:
    s_sub_u32 s10, s10, 1
    s_cbranch_scc1 L_give98
    buffer_load_dwordx4 v[8:11], v1, s[12:15], s66 offen offset:0 sc1
    buffer_load_dwordx4 v[12:15], v1, s[12:15], s66 offen offset:256 sc1
    buffer_load_dwordx4 v[16:19], v1, s[12:15], s66 offen offset:512 sc1
    buffer_load_dwordx4 v[20:23], v1, s[12:15], s66 offen offset:768 sc1
    buffer_load_dwordx4 v[24:27], v1, s[12:15], s66 offen offset:1024 sc1
    s_waitcnt vmcnt(0) lgkmcnt(0)
    v_max3_u32 v7, v11, v15, v19
    v_max3_u32 v7, v7, v23, v27
    v_cmp_eq_u32 vcc, -1, v7
    s_cbranch_vccnz L_retry96
    v_mfma_f32_16x16x32_bf16 v[52:55], v[32:35], v[8:11], 0
    v_max3_u32 v7, v8, v9, v10
    v_max3_u32 v7, v7, v11, v12
    v_mfma_f32_16x16x32_bf16 v[52:55], v[36:39], v[12:15], v[52:55]
    v_max3_u32 v7, v7, v13, v14
    v_max3_u32 v7, v7, v15, v16
    v_mfma_f32_16x16x32_bf16 v[52:55], v[40:43], v[16:19], v[52:55]
    v_max3_u32 v7, v7, v17, v18
    v_max3_u32 v7, v7, v19, v20
    v_mfma_f32_16x16x32_bf16 v[52:55], v[44:47], v[20:23], v[52:55]
    v_max3_u32 v7, v7, v21, v22
    v_max3_u32 v7, v7, v23, v24
    v_mfma_f32_16x16x32_bf16 v[52:55], v[48:51], v[24:27], v[52:55]
    v_max3_u32 v7, v7, v25, v26
    v_max_u32 v7, v7, v27
    v_cmp_eq_u32 vcc, -1, v7
    s_cbranch_vccnz L_retry96
L_ok97:
    s_cmp_eq_u32 s3, 0
    s_cbranch_scc0 L_gu_rest
    buffer_load_dwordx2 v[16:17], v62, s[12:15], s67 offen sc1
    buffer_load_dwordx2 v[18:19], v63, s[12:15], s67 offen sc1
    ds_write_b128 v56, v[52:55]
    s_waitcnt lgkmcnt(0)
    s_barrier
    ds_read_b128 v[8:11], v57
    ds_read_b128 v[12:15], v57 offset:256
    s_waitcnt vmcnt(0)
    v_pk_add_f32 v[20:21], v[16:17], v[18:19]
    v_cmp_u_f32 vcc, v20, v21
    s_cbranch_vccnz L_stre99
L_stok100:
    v_add_f32_dpp v20, v20, v20 row_ror:8 row_mask:0xf bank_mask:0xf
    v_add_f32_dpp v21, v21, v21 row_ror:8 row_mask:0xf bank_mask:0xf
    s_nop 0
    v_add_f32_dpp v20, v20, v20 row_ror:4 row_mask:0xf bank_mask:0xf
    v_add_f32_dpp v21, v21, v21 row_ror:4 row_mask:0xf bank_mask:0xf
    s_waitcnt lgkmcnt(0)
    v_add_f32_dpp v8, v8, v8 row_ror:8 row_mask:0xf bank_mask:0x3
    v_add_f32_dpp v12, v12, v12 row_ror:8 row_mask:0xf bank_mask:0x3
    v_add_f32_dpp v20, v20, v20 row_ror:2 row_mask:0xf bank_mask:0xf
    v_add_f32_dpp v9, v9, v9 row_ror:8 row_mask:0xf bank_mask:0x3
    v_add_f32_dpp v21, v21, v21 row_ror:2 row_mask:0xf bank_mask:0xf
    v_add_f32_dpp v13, v13, v13 row_ror:8 row_mask:0xf bank_mask:0x3
    v_add_f32_dpp v20, v20, v20 row_ror:1 row_mask:0xf bank_mask:0xf
    v_add_f32_dpp v8, v10, v10 row_ror:8 row_mask:0xf bank_mask:0xc
    v_add_f32_dpp v21, v21, v21 row_ror:1 row_mask:0xf bank_mask:0xf
    v_add_f32_dpp v12, v14, v14 row_ror:8 row_mask:0xf bank_mask:0xc
    v_mul_f32 v20, 0x3acccccd, v20
    v_add_f32_dpp v9, v11, v11 row_ror:8 row_mask:0xf bank_mask:0xc
    v_add_f32_dpp v13, v15, v15 row_ror:8 row_mask:0xf bank_mask:0xc
    v_mul_f32 v21, 0x3acccccd, v21
    v_add_f32_dpp v8, v8, v8 row_shl:4 row_mask:0xf bank_mask:0x5
    v_fma_f32 v22, -v20, v20, v21
    v_add_f32_dpp v12, v12, v12 row_shl:4 row_mask:0xf bank_mask:0x5
    v_max_f32 v22, 0, v22
    v_add_f32_dpp v8, v9, v9 row_shr:4 row_mask:0xf bank_mask:0xa
    v_add_f32 v22, 0x3727c5ac, v22
    v_add_f32_dpp v12, v13, v13 row_shr:4 row_mask:0xf bank_mask:0xa
    v_rsq_f32 v21, v22
    v_fma_f32 v8, -v20, v4, v8
    v_fma_f32 v12, -v20, v5, v12
    v_mul_f32 v8, v8, v21
    v_mul_f32 v12, v12, v21
    v_mul_f32 v9, 0xbfb8aa3b, v8
    v_exp_f32 v9, v9
    v_mul_f32 v8, v8, v12
    v_add_f32 v9, 1.0, v9
    v_rcp_f32 v9, v9
    s_cmp_eq_u32 s9, 0
    v_mul_f32 v8, v8, v9
    s_nop 1
    v_mov_b32_dpp v9, v8 row_shl:4 row_mask:0xf bank_mask:0x5
    v_cvt_pk_bf16_f32 v8, v8, v9
    s_cbranch_scc1 L_slow102
    buffer_store_dword v8, v58, s[12:15], s65 offen
L_back103:
    s_branch L_gu_done
L_stre99:
    v_max3_u32 v7, v16, v17, v18
    v_max_u32 v7, v7, v19
    v_cmp_eq_u32 vcc, -1, v7
    s_cbranch_vccz L_stok100
    s_sub_u32 s10, s10, 1
    s_cbranch_scc1 L_give101
    buffer_load_dwordx2 v[16:17], v62, s[12:15], s67 offen sc1
    buffer_load_dwordx2 v[18:19], v63, s[12:15], s67 offen sc1
    s_waitcnt vmcnt(0)
    v_pk_add_f32 v[20:21], v[16:17], v[18:19]
    s_branch L_stre99
L_give101:
    s_mov_b32 s10, 0
    s_nop 1
    s_branch L_stok100
L_gu_rest:
    s_nop 1
    ds_write_b128 v56, v[52:55]
    s_waitcnt lgkmcnt(0)
    s_barrier
L_gu_done:
    s_cmp_eq_u32 s8, 0
    s_cbranch_scc0 L_fin
    s_sub_u32 s70, s3, 1
    s_cmp_lt_u32 s70, 6
    s_cbranch_scc0 L_noq104
    ds_read_b128 v[56:59], v3 offset:17792
    s_lshl_b32 s70, s70, 6
    s_waitcnt lgkmcnt(0)
    v_add_u32 v58, s70, v58
    v_add_u32 v59, s70, v59
    ds_read_b64_tr_b16 v[32:33], v58 offset:0
    ds_read_b64_tr_b16 v[34:35], v58 offset:1536
    ds_read_b64_tr_b16 v[36:37], v58 offset:12288
    ds_read_b64_tr_b16 v[38:39], v58 offset:13824
    ds_read_b64_tr_b16 v[40:41], v59 offset:24576
    ds_read_b64_tr_b16 v[42:43], v59 offset:26112
    ds_read_b64_tr_b16 v[44:45], v58 offset:32
    ds_read_b64_tr_b16 v[46:47], v58 offset:1568
    ds_read_b64_tr_b16 v[48:49], v58 offset:12320
    ds_read_b64_tr_b16 v[50:51], v58 offset:13856
    ds_read_b64_tr_b16 v[52:53], v59 offset:24608
    ds_read_b64_tr_b16 v[54:55], v59 offset:26144
L_noq104:
    s_cmp_eq_u32 s3, 7
    s_cbranch_scc0 L_no7105
    v_mov_b32 v7, 592
    ds_read_b64 v[62:63], v7
    ds_read_b128 v[56:59], v3 offset:15744
    v_lshlrev_b32 v60, 5, v0
    s_mul_i32 s70, s4, 49152
    s_mul_i32 s71, s6, 12288
    s_add_u32 s70, s70, s71
    s_add_u32 s70, s70, 2293760
    v_mov_b32 v44, 0
    v_mov_b32 v45, 0
    v_mov_b32 v46, 0
    v_mov_b32 v47, 0
    s_mov_b32 exec_lo, 0xffffffff
    s_mov_b32 exec_hi, 0xffff
L_retry106:
    s_sub_u32 s10, s10, 1
    s_cbranch_scc1 L_give108
    buffer_load_dwordx4 v[8:11], v60, s[12:15], s70 offen offset:0 sc1
    buffer_load_dwordx4 v[12:15], v60, s[12:15], s70 offen offset:16 sc1
    buffer_load_dwordx4 v[16:19], v60, s[12:15], s70 offen offset:1536 sc1
    buffer_load_dwordx4 v[20:23], v60, s[12:15], s70 offen offset:1552 sc1
    s_add_u32 s69, s70, 3072
    buffer_load_dwordx4 v[24:27], v60, s[12:15], s69 offen sc1
    buffer_load_dwordx4 v[28:31], v60, s[12:15], s69 offen offset:16 sc1
    buffer_load_dwordx4 v[32:35], v60, s[12:15], s69 offen offset:1536 sc1
    buffer_load_dwordx4 v[36:39], v60, s[12:15], s69 offen offset:1552 sc1
    v_mov_b32 v7, 0
    s_waitcnt vmcnt(0) lgkmcnt(0)
    v_xor_b32 v10, v62, v10
    v_xor_b32 v11, v63, v11
    v_or3_b32 v7, v7, v10, v11
    v_xor_b32 v14, v62, v14
    v_xor_b32 v15, v63, v15
    v_or3_b32 v7, v7, v14, v15
    v_xor_b32 v18, v62, v18
    v_xor_b32 v19, v63, v19
    v_or3_b32 v7, v7, v18, v19
    v_xor_b32 v22, v62, v22
    v_xor_b32 v23, v63, v23
    v_or3_b32 v7, v7, v22, v23
    v_xor_b32 v26, v62, v26
    v_xor_b32 v27, v63, v27
    v_or3_b32 v7, v7, v26, v27
    v_xor_b32 v30, v62, v30
    v_xor_b32 v31, v63, v31
    v_or3_b32 v7, v7, v30, v31
    v_xor_b32 v34, v62, v34
    v_xor_b32 v35, v63, v35
    v_or3_b32 v7, v7, v34, v35
    v_xor_b32 v38, v62, v38
    v_xor_b32 v39, v63, v39
    v_or3_b32 v7, v7, v38, v39
    v_cmp_ne_u32 vcc, 0, v7
    s_cbranch_vccnz L_retry106
L_ok107:
    v_pk_add_f32 v[44:45], v[44:45], v[8:9]
    v_pk_add_f32 v[46:47], v[46:47], v[12:13]
    v_pk_add_f32 v[44:45], v[44:45], v[16:17]
    v_pk_add_f32 v[46:47], v[46:47], v[20:21]
    v_pk_add_f32 v[44:45], v[44:45], v[24:25]
    v_pk_add_f32 v[46:47], v[46:47], v[28:29]
    v_pk_add_f32 v[44:45], v[44:45], v[32:33]
    v_pk_add_f32 v[46:47], v[46:47], v[36:37]
    s_add_u32 s70, s70, 6144
L_retry109:
    s_sub_u32 s10, s10, 1
    s_cbranch_scc1 L_give111
    buffer_load_dwordx4 v[8:11], v60, s[12:15], s70 offen offset:0 sc1
    buffer_load_dwordx4 v[12:15], v60, s[12:15], s70 offen offset:16 sc1
    buffer_load_dwordx4 v[16:19], v60, s[12:15], s70 offen offset:1536 sc1
    buffer_load_dwordx4 v[20:23], v60, s[12:15], s70 offen offset:1552 sc1
    s_add_u32 s69, s70, 3072
    buffer_load_dwordx4 v[24:27], v60, s[12:15], s69 offen sc1
    buffer_load_dwordx4 v[28:31], v60, s[12:15], s69 offen offset:16 sc1
    buffer_load_dwordx4 v[32:35], v60, s[12:15], s69 offen offset:1536 sc1
    buffer_load_dwordx4 v[36:39], v60, s[12:15], s69 offen offset:1552 sc1
    v_mov_b32 v7, 0
    s_waitcnt vmcnt(0) lgkmcnt(0)
    v_xor_b32 v10, v62, v10
    v_xor_b32 v11, v63, v11
    v_or3_b32 v7, v7, v10, v11
    v_xor_b32 v14, v62, v14
    v_xor_b32 v15, v63, v15
    v_or3_b32 v7, v7, v14, v15
    v_xor_b32 v18, v62, v18
    v_xor_b32 v19, v63, v19
    v_or3_b32 v7, v7, v18, v19
    v_xor_b32 v22, v62, v22
    v_xor_b32 v23, v63, v23
    v_or3_b32 v7, v7, v22, v23
    v_xor_b32 v26, v62, v26
    v_xor_b32 v27, v63, v27
    v_or3_b32 v7, v7, v26, v27
    v_xor_b32 v30, v62, v30
    v_xor_b32 v31, v63, v31
    v_or3_b32 v7, v7, v30, v31
    v_xor_b32 v34, v62, v34
    v_xor_b32 v35, v63, v35
    v_or3_b32 v7, v7, v34, v35
    v_xor_b32 v38, v62, v38
    v_xor_b32 v39, v63, v39
    v_or3_b32 v7, v7, v38, v39
    v_cmp_ne_u32 vcc, 0, v7
    s_cbranch_vccnz L_retry109
L_ok110:
    v_pk_add_f32 v[44:45], v[44:45], v[8:9]
    v_pk_add_f32 v[46:47], v[46:47], v[12:13]
    v_pk_add_f32 v[44:45], v[44:45], v[16:17]
    v_pk_add_f32 v[46:47], v[46:47], v[20:21]
    v_pk_add_f32 v[44:45], v[44:45], v[24:25]
    v_pk_add_f32 v[46:47], v[46:47], v[28:29]
    v_pk_add_f32 v[44:45], v[44:45], v[32:33]
    v_pk_add_f32 v[46:47], v[46:47], v[36:37]
    s_add_u32 s70, s70, 6144
    s_mov_b64 exec, -1
L_no7105:
L_q2:
    s_mul_i32 s66, s7, 640
    s_add_u32 s66, s66, s58
    s_add_u32 s66, s66, 20480
    s_add_u32 s67, s58, 25600
    s_mul_i32 s68, s4, 98304
    s_mul_i32 s71, s6, 24576
    s_add_u32 s68, s68, s71
    s_add_u32 s68, s68, 720896
    s_mov_b32 s8, 1
    s_add_u32 s59, s59, 339968
    s_mul_i32 s58, s4, 20480
    s_add_u32 s58, s58, 393216
    s_cmp_eq_u32 s3, 0
    s_cbranch_scc1 L_q2_done
    s_cmp_eq_u32 s3, 7
    s_cbranch_scc1 L_q2_cons
    s_mul_i32 s69, s7, 768
    s_lshl_b32 s71, s3, 7
    s_add_u32 s69, s69, s71
    s_add_u32 s69, s69, s68
    s_add_u32 s69, s69, 4294967168
L_retry112:
    s_sub_u32 s10, s10, 1
    s_cbranch_scc1 L_give114
    buffer_load_dwordx4 v[8:11], v1, s[12:15], s66 offen offset:0 sc1
    buffer_load_dwordx4 v[12:15], v1, s[12:15], s66 offen offset:256 sc1
    buffer_load_dwordx4 v[16:19], v56, s[12:15], s66 offen offset:512 sc1
    s_cmp_eq_u32 s9, 0
    s_waitcnt vmcnt(0) lgkmcnt(0)
    v_max3_u32 v7, v11, v15, v19
    v_cmp_eq_u32 vcc, -1, v7
    s_cbranch_vccnz L_retry112
    v_mfma_f32_16x16x32_bf16 v[20:23], v[32:35], v[8:11], 0
    v_max3_u32 v7, v8, v9, v10
    v_mfma_f32_16x16x32_bf16 v[24:27], v[44:47], v[8:11], 0
    v_max3_u32 v7, v7, v11, v12
    v_mfma_f32_16x16x32_bf16 v[20:23], v[36:39], v[12:15], v[20:23]
    v_max3_u32 v7, v7, v13, v14
    v_mfma_f32_16x16x32_bf16 v[24:27], v[48:51], v[12:15], v[24:27]
    v_max3_u32 v7, v7, v15, v16
    v_mfma_f32_16x16x32_bf16 v[20:23], v[40:43], v[16:19], v[20:23]
    v_max3_u32 v7, v7, v17, v18
    v_mfma_f32_16x16x32_bf16 v[24:27], v[52:55], v[16:19], v[24:27]
    v_max_u32 v7, v7, v19
    v_cmp_eq_u32 vcc, -1, v7
    s_cbranch_vccnz L_retry112
L_ok113:
    s_cbranch_scc1 L_slow115
    s_nop 1
    buffer_store_dwordx4 v[20:23], v57, s[12:15], s69 offen
    s_nop 0
    buffer_store_dwordx4 v[24:27], v57, s[12:15], s69 offen offset:64
L_back116:
L_q2_done:
    ds_read_b128 v[32:35], v3 offset:9600
    ds_read_b128 v[36:39], v3 offset:10624
    ds_read_b128 v[60:63], v3 offset:11648
    v_mov_b64 v[48:49], 0
    v_mov_b64 v[50:51], 0
    v_mov_b64 v[52:53], 0
    v_mov_b64 v[54:55], 0
    v_mov_b64 v[56:57], 0
    v_mov_b64 v[58:59], 0
    s_mul_i32 s67, s3, 1664
    s_mul_i32 s63, s3, 6144
    s_mul_i32 s20, s6, 3072
    s_mul_i32 s71, s3, 384
    s_add_u32 s20, s20, s71
    s_lshl_b32 s71, s11, 4
    s_add_u32 s20, s20, s71
    s_add_u32 s20, s20, s58
    s_lshl_b32 s21, s6, 6
    s_lshl_b32 s71, s11, 3
    s_add_u32 s21, s21, s71
    s_add_u32 s21, s21, s58
    s_add_u32 s21, s21, 12288
    s_lshl_b32 s22, s3, 4
    s_mul_i32 s23, s3, 96
    s_mul_i32 s24, s3, 1536
    s_add_u32 s24, s24, s58
    s_lshl_b32 s25, s61, 6
    s_add_u32 s25, s25, s58
    s_add_u32 s25, s25, 12288
    s_lshl_b32 s26, s3, 9
    s_lshl_b32 s27, s4, 9
    s_add_u32 s27, s27, s59
    s_lshl_b32 s75, s8, 4
    s_add_u32 s75, s75, s3
    s_add_u32 s75, s75, 4294967295
    v_mov_b32 v7, s73
    s_waitcnt lgkmcnt(0)
    v_add_u32 v63, s63, v63
    s_setprio 2
    s_branch L_q2_join
L_q2_cons:
    s_setprio 3
L_retry117:
    s_sub_u32 s10, s10, 1
    s_cbranch_scc1 L_give119
    buffer_load_dwordx2 v[16:17], v58, s[12:15], s67 offen sc1
    buffer_load_dwordx2 v[20:21], v59, s[12:15], s67 offen sc1
    s_waitcnt vmcnt(0)
    v_max3_u32 v7, v16, v17, v20
    v_max_u32 v7, v7, v21
    v_cmp_eq_u32 vcc, -1, v7
    s_cbranch_vccnz L_retry117
L_ok118:
    v_pk_add_f32 v[16:17], v[16:17], v[20:21]
    s_nop 1
    v_add_f32_dpp v16, v16, v16 row_ror:8 row_mask:0xf bank_mask:0xf
    v_add_f32_dpp v17, v17, v17 row_ror:8 row_mask:0xf bank_mask:0xf
    s_nop 0
    v_add_f32_dpp v16, v16, v16 row_ror:4 row_mask:0xf bank_mask:0xf
    v_add_f32_dpp v17, v17, v17 row_ror:4 row_mask:0xf bank_mask:0xf
    s_nop 0
    v_add_f32_dpp v16, v16, v16 row_ror:2 row_mask:0xf bank_mask:0xf
    v_add_f32_dpp v17, v17, v17 row_ror:2 row_mask:0xf bank_mask:0xf
    s_nop 0
    v_add_f32_dpp v16, v16, v16 row_ror:1 row_mask:0xf bank_mask:0xf
    v_add_f32_dpp v17, v17, v17 row_ror:1 row_mask:0xf bank_mask:0xf
    v_mul_f32 v16, 0x3acccccd, v16
    v_mul_f32 v17, 0x3acccccd, v17
    v_fma_f32 v20, -v16, v16, v17
    v_max_f32 v20, 0, v20
    v_add_f32 v20, 0x3727c5ac, v20
    v_rsq_f32 v17, v20
    s_lshl_b32 s70, s72, 4
    v_readlane_b32 s64, v16, s70
    v_readlane_b32 s65, v17, s70
    s_nop 0
    v_mul_f32 v44, s64, v44
    v_mul_f32 v45, s64, v45
    v_mul_f32 v46, s64, v46
    v_mul_f32 v47, s64, v47
    s_mul_i32 s69, s72, 6144
    s_add_u32 s68, s68, s69
    s_add_u32 s69, s68, 3072
    ds_read_b128 v[32:35], v3 offset:9600
    ds_read_b128 v[36:39], v3 offset:10624
    ds_read_b128 v[60:63], v3 offset:11648
    v_mov_b64 v[48:49], 0
    v_mov_b64 v[50:51], 0
    v_mov_b64 v[52:53], 0
    v_mov_b64 v[54:55], 0
    v_mov_b64 v[56:57], 0
    v_mov_b64 v[58:59], 0
    s_mul_i32 s67, s3, 1664
    s_mul_i32 s63, s3, 6144
    s_mul_i32 s20, s6, 3072
    s_mul_i32 s71, s3, 384
    s_add_u32 s20, s20, s71
    s_lshl_b32 s71, s11, 4
    s_add_u32 s20, s20, s71
    s_add_u32 s20, s20, s58
    s_lshl_b32 s21, s6, 6
    s_lshl_b32 s71, s11, 3
    s_add_u32 s21, s21, s71
    s_add_u32 s21, s21, s58
    s_add_u32 s21, s21, 12288
    s_lshl_b32 s22, s3, 4
    s_mul_i32 s23, s3, 96
    s_mul_i32 s24, s3, 1536
    s_add_u32 s24, s24, s58
    s_lshl_b32 s25, s61, 6
    s_add_u32 s25, s25, s58
    s_add_u32 s25, s25, 12288
    s_lshl_b32 s26, s3, 9
    s_lshl_b32 s27, s4, 9
    s_add_u32 s27, s27, s59
    s_lshl_b32 s75, s8, 4
    s_add_u32 s75, s75, s3
    s_add_u32 s75, s75, 4294967295
    v_mov_b32 v7, s73
    s_waitcnt lgkmcnt(0)
    v_add_u32 v63, s63, v63
    s_setprio 2
    s_setprio 3
    v_lshlrev_b32 v38, 3, v0
    v_mov_b32 v4, s65
    s_mov_b32 exec_lo, 0xffffffff
    s_mov_b32 exec_hi, 0xffff
    s_or_b32 s10, s10, 31
L_nan120:
    s_sub_u32 s10, s10, 1
    s_and_b32 s71, s10, 31
    s_cbranch_scc0 L_exact123
L_retry121:
    buffer_load_dwordx4 v[8:11], v3, s[12:15], s68 offen offset:0 sc1
    buffer_load_dwordx4 v[12:15], v3, s[12:15], s68 offen offset:768 sc1
    buffer_load_dwordx4 v[16:19], v3, s[12:15], s68 offen offset:1536 sc1
    buffer_load_dwordx4 v[20:23], v3, s[12:15], s68 offen offset:2304 sc1
    buffer_load_dwordx4 v[24:27], v3, s[12:15], s69 offen offset:0 sc1
    buffer_load_dwordx4 v[28:31], v3, s[12:15], s69 offen offset:768 sc1
    buffer_load_dwordx4 v[40:43], v3, s[12:15], s69 offen offset:1536 sc1
    buffer_load_dwordx4 v[48:51], v3, s[12:15], s69 offen offset:2304 sc1
    s_waitcnt vmcnt(6)
    v_pk_add_f32 v[52:53], v[8:9], v[12:13]
    v_pk_add_f32 v[54:55], v[10:11], v[14:15]
    s_waitcnt vmcnt(5)
    v_pk_add_f32 v[52:53], v[52:53], v[16:17]
    v_pk_add_f32 v[54:55], v[54:55], v[18:19]
    s_waitcnt vmcnt(4)
    v_pk_add_f32 v[52:53], v[52:53], v[20:21]
    v_pk_add_f32 v[54:55], v[54:55], v[22:23]
    s_waitcnt vmcnt(3)
    v_pk_add_f32 v[52:53], v[52:53], v[24:25]
    v_pk_add_f32 v[54:55], v[54:55], v[26:27]
    s_waitcnt vmcnt(2)
    v_pk_add_f32 v[52:53], v[52:53], v[28:29]
    v_pk_add_f32 v[54:55], v[54:55], v[30:31]
    s_waitcnt vmcnt(1)
    v_pk_add_f32 v[52:53], v[52:53], v[40:41]
    v_pk_add_f32 v[54:55], v[54:55], v[42:43]
    s_waitcnt vmcnt(0)
    v_pk_add_f32 v[52:53], v[52:53], v[48:49]
    v_pk_add_f32 v[54:55], v[54:55], v[50:51]
    v_pk_add_f32 v[56:57], v[52:53], v[54:55]
    v_pk_add_f32 v[52:53], v[52:53], v[44:45] neg_lo:[0,1] neg_hi:[0,1]
    v_cmp_u_f32 vcc, v56, v57
    v_pk_add_f32 v[54:55], v[54:55], v[46:47] neg_lo:[0,1] neg_hi:[0,1]
    s_cbranch_vccnz L_nan120
L_ok122:
    v_pk_mul_f32 v[52:53], v[52:53], v[4:5] op_sel_hi:[1,0]
    v_pk_mul_f32 v[54:55], v[54:55], v[4:5] op_sel_hi:[1,0]
    v_cvt_pk_bf16_f32 v56, v52, v53
    v_cvt_pk_bf16_f32 v57, v54, v55
    ds_write_b64 v38, v[56:57] offset:128
    s_mov_b64 exec, -1
    v_mov_b64 v[48:49], 0
    v_mov_b64 v[50:51], 0
    v_mov_b64 v[52:53], 0
    v_mov_b64 v[54:55], 0
    v_mov_b64 v[56:57], 0
    s_setprio 2
    s_waitcnt lgkmcnt(0)
L_q2_join:
    s_barrier
    ds_read_b128 v[8:11], v32
    ds_read_b128 v[12:15], v33
    ds_read_b128 v[16:19], v34
    ds_read_b128 v[20:23], v35
    ds_read_b128 v[24:27], v36
    ds_read_b128 v[28:31], v37
    s_branch L_att
L_fin:
L_end:
    s_endpgm
L_aside1:
    s_setprio 3
    v_mov_b32 v38, 2689024
    global_load_dwordx2 v[38:39], v38, s[56:57] sc1
    v_mov_b32 v32, -1
    v_mov_b32 v33, -1
    v_mov_b32 v34, -1
    v_mov_b32 v35, -1
    s_mul_i32 s70, s2, 1536
    v_lshl_add_u32 v36, v0, 4, s70
    global_store_dwordx4 v36, v[32:35], s[56:57] sc1
    s_mov_b32 exec_hi, 0
    global_store_dwordx4 v36, v[32:35], s[56:57] offset:1024 sc1
    s_mov_b32 exec_hi, -1
    s_lshl_b32 s68, s4, 8
    s_lshl_b32 s71, s5, 3
    s_add_u32 s68, s68, s71
    s_add_u32 s68, s68, 2686976
    v_mov_b32 v14, s68
    s_waitcnt vmcnt(0)
    v_readfirstlane_b32 s66, v38
    v_readfirstlane_b32 s67, v39
    s_mul_i32 s42, s66, 0x9e3779b1
    s_add_u32 s42, s42, 0x7f4a7c15
    s_xor_b32 s67, s67, s42
    s_mul_i32 s43, s67, 0x85ebca6b
    s_add_u32 s43, s43, 0xc2b2ae35
    s_getreg_b32 s67, hwreg(HW_REG_XCC_ID, 0, 4)
    s_add_u32 s67, s67, s43
    v_mov_b32 v16, s42
    v_mov_b32 v17, s67
    s_mov_b64 exec, 1
    global_store_dwordx2 v14, v[16:17], s[56:57] sc1
    s_mov_b64 exec, -1
    s_and_b32 s69, s5, 7
    s_mul_i32 s68, s4, 49152
    s_mul_i32 s71, s6, 12288
    s_add_u32 s68, s68, s71
    s_mul_i32 s71, s69, 1536
    s_add_u32 s68, s68, s71
    s_add_u32 s68, s68, 2293760
    v_lshl_add_u32 v14, v0, 7, s68
    s_mov_b32 exec_lo, 0xfff
    s_mov_b32 exec_hi, 0x0
    global_load_dword v14, v14, s[56:57] sc1
    s_mov_b64 exec, -1
    s_branch L_ret2
L_give5:
    s_mov_b32 s10, 0
    s_branch L_ok4
L_give8:
    s_mov_b32 s10, 0
    s_branch L_ok7
L_slow9:
    s_nop 7
    buffer_store_dwordx4 v[24:27], v3, s[12:15], s67 offen sc1
    s_branch L_back10
L_give13:
    s_mov_b32 s10, 0
    s_branch L_ok12
L_give16:
    s_mov_b32 s10, 0
    s_branch L_ok15
L_give19:
    s_mov_b32 s10, 0
    s_branch L_ok18
L_slow20:
    s_nop 7
    buffer_store_dwordx4 v[8:11], v32, s[12:15], s70 offen sc1
    buffer_store_dwordx4 v[12:15], v33, s[12:15], s70 offen sc1
    buffer_store_dwordx4 v[16:19], v34, s[12:15], s70 offen sc1
    s_branch L_back21
L_give24:
    s_mov_b32 s10, 0
    s_branch L_ok23
L_give31:
    s_mov_b32 s10, 0
    s_branch L_ok30
L_give34:
    s_mov_b32 s10, 0
    s_branch L_ok33
L_aside27:
    s_cmp_eq_u32 s3, 1
    s_cbranch_scc0 L_not4
    s_mov_b32 exec_lo, 0xff
    s_mov_b32 exec_hi, 0x0
    s_mul_i32 s68, s5, 848
    s_add_u32 s68, s68, s58
    v_lshlrev_b32 v28, 7, v0
    buffer_load_dword v40, v28, s[12:15], s68 offen sc1
    s_mov_b64 exec, -1
L_not4:
    s_cmp_eq_u32 s3, 3
    s_cbranch_scc0 L_not3
    s_getpc_b64 s[70:71]
L_pc:
    s_sub_u32 s70, s70, L_pc-interleave_layers__sliding_block_cached__moe_arch_mod__decode_kernel
    s_subb_u32 s71, s71, 0
    s_lshl_b32 s69, s5, 10
    v_add_u32 v28, s69, v3
    v_min_u32 v28, L_codeend-interleave_layers__sliding_block_cached__moe_arch_mod__decode_kernel-16, v28
    global_load_dwordx4 v[40:43], v28, s[70:71]
L_not3:
    s_cmp_lt_u32 s5, 20
    s_cbranch_scc0 L_pre_gu
    s_mov_b32 s16, s40
    s_mov_b32 s17, s41
    s_mov_b32 s18, 7864320
    s_mov_b32 s19, 0x20000
    v_lshrrev_b32 v28, 2, v0
    v_mul_u32_u24 v28, 1280, v28
    v_and_b32 v29, 3, v0
    v_lshl_add_u32 v28, v29, 4, v28
    s_and_b32 s69, s5, 1
    s_mul_i32 s69, s69, 3
    v_mov_b32 v30, 576
L_retry29:
    s_sub_u32 s10, s10, 1
    s_cbranch_scc1 L_give31
    s_sleep 1
    ds_read_b32 v31, v30 offset:12
    s_waitcnt lgkmcnt(0)
    v_cmp_ne_u32 vcc, 4, v31
    s_cbranch_vccnz L_retry29
L_ok30:
    s_mul_i32 s67, s4, 983040
    s_lshl_b32 s71, s5, 6
    s_add_u32 s67, s67, s71
    s_mul_i32 s71, s3, 122880
    s_add_u32 s67, s67, s71
    s_add_u32 s67, s67, 4294844416
    s_mul_i32 s68, s3, 6144
    s_add_u32 s68, s68, 57728
    s_add_u32 s70, s69, 0
    s_sub_u32 s71, s70, 6
    s_cselect_b32 s70, s70, s71
    s_mul_i32 s71, s70, 20480
    s_lshl_b32 s70, s70, 10
    s_add_u32 m0, s70, s68
    s_add_u32 s71, s71, s67
    buffer_load_dwordx4 v28, s[16:19], s71 offen lds
    s_add_u32 s70, s69, 1
    s_sub_u32 s71, s70, 6
    s_cselect_b32 s70, s70, s71
    s_mul_i32 s71, s70, 20480
    s_lshl_b32 s70, s70, 10
    s_add_u32 m0, s70, s68
    s_add_u32 s71, s71, s67
    buffer_load_dwordx4 v28, s[16:19], s71 offen lds
    s_add_u32 s70, s69, 2
    s_sub_u32 s71, s70, 6
    s_cselect_b32 s70, s70, s71
    s_mul_i32 s71, s70, 20480
    s_lshl_b32 s70, s70, 10
    s_add_u32 m0, s70, s68
    s_add_u32 s71, s71, s67
    buffer_load_dwordx4 v28, s[16:19], s71 offen lds
    s_add_u32 s70, s69, 3
    s_sub_u32 s71, s70, 6
    s_cselect_b32 s70, s70, s71
    s_mul_i32 s71, s70, 20480
    s_lshl_b32 s70, s70, 10
    s_add_u32 m0, s70, s68
    s_add_u32 s71, s71, s67
    buffer_load_dwordx4 v28, s[16:19], s71 offen lds
    s_mul_i32 s67, s4, 983040
    s_lshl_b32 s71, s5, 6
    s_add_u32 s67, s67, s71
    s_mul_i32 s71, s3, 122880
    s_add_u32 s67, s67, s71
    s_add_u32 s67, s67, 368640
    s_mul_i32 s68, s3, 6144
    s_add_u32 s68, s68, 82304
    s_add_u32 s70, s69, 0
    s_sub_u32 s71, s70, 6
    s_cselect_b32 s70, s70, s71
    s_mul_i32 s71, s70, 20480
    s_lshl_b32 s70, s70, 10
    s_add_u32 m0, s70, s68
    s_add_u32 s71, s71, s67
    buffer_load_dwordx4 v28, s[16:19], s71 offen lds
    s_add_u32 s70, s69, 1
    s_sub_u32 s71, s70, 6
    s_cselect_b32 s70, s70, s71
    s_mul_i32 s71, s70, 20480
    s_lshl_b32 s70, s70, 10
    s_add_u32 m0, s70, s68
    s_add_u32 s71, s71, s67
    buffer_load_dwordx4 v28, s[16:19], s71 offen lds
    s_add_u32 s70, s69, 2
    s_sub_u32 s71, s70, 6
    s_cselect_b32 s70, s70, s71
    s_mul_i32 s71, s70, 20480
    s_lshl_b32 s70, s70, 10
    s_add_u32 m0, s70, s68
    s_add_u32 s71, s71, s67
    buffer_load_dwordx4 v28, s[16:19], s71 offen lds
    s_add_u32 s70, s69, 3
    s_sub_u32 s71, s70, 6
    s_cselect_b32 s70, s70, s71
    s_mul_i32 s71, s70, 20480
    s_lshl_b32 s70, s70, 10
    s_add_u32 m0, s70, s68
    s_add_u32 s71, s71, s67
    buffer_load_dwordx4 v28, s[16:19], s71 offen lds
    s_branch L_ret28
L_pre_gu:
    s_xor_b32 s64, s60, 1
    s_cmp_eq_u32 s64, 0
    s_cselect_b32 s16, s46, s48
    s_cselect_b32 s17, s47, s49
    s_mov_b32 s18, 1966080
    s_mov_b32 s19, 0x20000
    v_lshrrev_b32 v28, 1, v0
    v_mul_u32_u24 v28, 3072, v28
    v_and_b32 v29, 1, v0
    v_lshl_add_u32 v28, v29, 4, v28
    s_and_b32 s69, s5, 3
    v_mov_b32 v30, 576
L_retry32:
    s_sub_u32 s10, s10, 1
    s_cbranch_scc1 L_give34
    s_sleep 1
    ds_read_b32 v31, v30 offset:12
    s_waitcnt lgkmcnt(0)
    v_cmp_ne_u32 vcc, 4, v31
    s_cbranch_vccnz L_retry32
L_ok33:
    s_add_u32 s64, s3, -1
    s_lshr_b32 s65, s64, 1
    s_mul_i32 s67, s4, 384
    s_lshl_b32 s71, s5, 5
    s_add_u32 s67, s67, s71
    s_mul_i32 s71, s65, 491520
    s_add_u32 s67, s67, s71
    s_add_u32 s67, s67, 4294966656
    s_mul_i32 s68, s64, 5120
    s_add_u32 s68, s68, 63872
    s_add_u32 s70, s69, 0
    s_sub_u32 s71, s70, 5
    s_cselect_b32 s70, s70, s71
    s_mul_i32 s71, s70, 98304
    s_lshl_b32 s70, s70, 10
    s_add_u32 m0, s70, s68
    s_add_u32 s71, s71, s67
    buffer_load_dwordx4 v28, s[16:19], s71 offen lds
    s_add_u32 s64, s3, 3
    s_lshr_b32 s65, s64, 1
    s_mul_i32 s67, s4, 384
    s_lshl_b32 s71, s5, 5
    s_add_u32 s67, s67, s71
    s_mul_i32 s71, s65, 491520
    s_add_u32 s67, s67, s71
    s_add_u32 s67, s67, 4294966656
    s_mul_i32 s68, s64, 5120
    s_add_u32 s68, s68, 63872
    s_add_u32 s70, s69, 0
    s_sub_u32 s71, s70, 5
    s_cselect_b32 s70, s70, s71
    s_mul_i32 s71, s70, 98304
    s_lshl_b32 s70, s70, 10
    s_add_u32 m0, s70, s68
    s_add_u32 s71, s71, s67
    buffer_load_dwordx4 v28, s[16:19], s71 offen lds
    s_cmp_eq_u32 s60, 0
    s_cselect_b32 s16, s46, s48
    s_cselect_b32 s17, s47, s49
    s_branch L_ret28
L_slow35:
    s_nop 7
    buffer_store_dword v8, v18, s[12:15], s20 offen sc1
    buffer_store_dwordx2 v[20:21], v19, s[12:15], s21 offen sc1
    s_branch L_back36
L_give39:
    s_mov_b32 s10, 0
    s_branch L_ok38
L_exact43:
    v_max3_u32 v7, v32, v33, v34
    v_max3_u32 v7, v7, v35, v36
    v_max3_u32 v7, v7, v37, v38
    v_max3_u32 v7, v7, v39, v40
    v_max3_u32 v7, v7, v41, v42
    v_max3_u32 v7, v7, v43, v44
    v_max3_u32 v7, v7, v45, v46
    v_max_u32 v7, v7, v47
    v_cmp_eq_u32 vcc, -1, v7
    s_cmp_eq_u32 s10, 0
    s_cbranch_scc1 L_ok42
    s_cmp_eq_u32 s9, 0
    s_cbranch_vccnz L_retry41
    s_branch L_ok42
L_slow44:
    s_nop 7
    buffer_store_dword v4, v63, s[12:15], s63 offen sc1
    s_branch L_back45
L_slow46:
    s_nop 7
    buffer_store_dword v48, v56, s[12:15], s64 offen sc1
    s_branch L_back47
L_give50:
    s_mov_b32 s10, 0
    s_branch L_ok49
L_exact54:
    v_max3_u32 v7, v32, v33, v34
    v_max3_u32 v7, v7, v35, v36
    v_max3_u32 v7, v7, v37, v38
    v_max3_u32 v7, v7, v39, v40
    v_max3_u32 v7, v7, v41, v42
    v_max3_u32 v7, v7, v43, v44
    v_max3_u32 v7, v7, v45, v46
    v_max_u32 v7, v7, v47
    v_cmp_eq_u32 vcc, -1, v7
    s_cmp_eq_u32 s10, 0
    s_cbranch_scc1 L_ok53
    s_cmp_eq_u32 s9, 0
    s_cbranch_vccnz L_retry52
    s_branch L_ok53
L_slow55:
    s_nop 7
    buffer_store_dword v4, v63, s[12:15], s63 offen sc1
    s_branch L_back56
L_slow57:
    s_nop 7
    buffer_store_dword v48, v56, s[12:15], s64 offen sc1
    s_branch L_back58
L_exact62:
    v_max3_u32 v7, v32, v33, v34
    v_max3_u32 v7, v7, v35, v36
    v_max3_u32 v7, v7, v37, v38
    v_max3_u32 v7, v7, v39, v40
    v_max3_u32 v7, v7, v41, v42
    v_max3_u32 v7, v7, v43, v44
    v_max3_u32 v7, v7, v45, v46
    v_max_u32 v7, v7, v47
    v_cmp_eq_u32 vcc, -1, v7
    s_cmp_eq_u32 s10, 0
    s_cbranch_scc1 L_ok61
    s_cmp_eq_u32 s9, 0
    s_cbranch_vccnz L_retry60
    s_branch L_ok61
L_slow64:
    s_nop 7
    buffer_store_dwordx4 v[8:11], v3, s[12:15], s69 offen sc1
    s_branch L_back65
L_slow66:
    s_nop 7
    buffer_store_dwordx4 v[12:15], v3, s[12:15], s69 offen offset:1024 sc1
    s_branch L_back67
L_give72:
    s_mov_b32 s10, 0
    s_branch L_ok71
L_give75:
    s_mov_b32 s10, 0
    s_branch L_ok74
L_give78:
    s_mov_b32 s10, 0
    s_branch L_ok77
L_give83:
    s_mov_b32 s10, 0
    s_branch L_ok82
L_give86:
    s_mov_b32 s10, 0
    s_branch L_ok85
L_slow87:
    s_nop 7
    buffer_store_dword v8, v18, s[12:15], s20 offen sc1
    buffer_store_dwordx2 v[20:21], v19, s[12:15], s21 offen sc1
    s_branch L_back88
L_slow89:
    s_nop 7
    buffer_store_dwordx4 v[24:27], v3, s[12:15], s31 offen sc1
    s_branch L_back90
L_slow92:
    s_nop 7
    buffer_store_dwordx4 v[8:11], v3, s[12:15], s69 offen sc1
    s_branch L_back93
L_slow94:
    s_nop 7
    buffer_store_dwordx4 v[12:15], v3, s[12:15], s69 offen offset:1024 sc1
    s_branch L_back95
L_give98:
    s_mov_b32 s10, 0
    s_branch L_ok97
L_slow102:
    s_nop 7
    buffer_store_dword v8, v58, s[12:15], s65 offen sc1
    s_branch L_back103
L_give108:
    s_mov_b32 s10, 0
    s_branch L_ok107
L_give111:
    s_mov_b32 s10, 0
    s_branch L_ok110
L_give114:
    s_mov_b32 s10, 0
    s_branch L_ok113
L_slow115:
    s_nop 7
    buffer_store_dwordx4 v[20:23], v57, s[12:15], s69 offen sc1
    buffer_store_dwordx4 v[24:27], v57, s[12:15], s69 offen offset:64 sc1
    s_branch L_back116
L_give119:
    s_mov_b32 s10, 0
    s_branch L_ok118
L_exact123:
    v_max3_u32 v39, v8, v9, v10
    v_max3_u32 v39, v39, v11, v12
    v_max3_u32 v39, v39, v13, v14
    v_max3_u32 v39, v39, v15, v16
    v_max3_u32 v39, v39, v17, v18
    v_max3_u32 v39, v39, v19, v20
    v_max3_u32 v39, v39, v21, v22
    v_max3_u32 v39, v39, v23, v24
    v_max3_u32 v39, v39, v25, v26
    v_max3_u32 v39, v39, v27, v28
    v_max3_u32 v39, v39, v29, v30
    v_max3_u32 v39, v39, v31, v40
    v_max3_u32 v39, v39, v41, v42
    v_max3_u32 v39, v39, v43, v48
    v_max3_u32 v39, v39, v49, v50
    v_max_u32 v39, v39, v51
    v_cmp_eq_u32 vcc, -1, v39
    s_cmp_eq_u32 s10, 0
    s_cbranch_scc1 L_ok122
    s_cmp_eq_u32 s9, 0
    s_cbranch_vccnz L_retry121
    s_branch L_ok122
L_codeend:
.section .rodata,"a"
.p2align 6
.amdhsa_kernel interleave_layers__sliding_block_cached__moe_arch_mod__decode_kernel
  .amdhsa_next_free_vgpr 256
  .amdhsa_next_free_sgpr 102
  .amdhsa_accum_offset 64
  .amdhsa_group_segment_fixed_size 0
  .amdhsa_kernarg_size 104
  .amdhsa_user_sgpr_count 2
  .amdhsa_user_sgpr_kernarg_segment_ptr 1
  .amdhsa_system_sgpr_workgroup_id_x 1
  .amdhsa_float_denorm_mode_32 3
.end_amdhsa_kernel
```
